```python
import torch

def _softmax(x, axis=-1):
    return torch.softmax(x, dim=axis)
def _gelu(x):
    return torch.nn.functional.gelu(x, approximate="tanh")
def _silu(x):
    return torch.nn.functional.silu(x)
def _sigmoid(x):
    return torch.sigmoid(x)
def _layernorm(x, axis=-1, eps=1e-5):
    m = x.mean(dim=axis, keepdim=True)
    v = x.var(dim=axis, keepdim=True, unbiased=False)
    return (x - m) / torch.sqrt(v + eps)
def _scatter_add(tgt, idx, src, axis=0):
    return tgt.clone().index_add_(axis, idx, src)
def _segment_sum(src, seg, n):
    out = torch.zeros((n,) + src.shape[1:], dtype=src.dtype)
    return out.index_add_(0, seg, src)
def _pad(x, pw):
    flat = tuple(v for pair in reversed(pw) for v in pair)
    return torch.nn.functional.pad(x, flat)

kernel_name = 'gated_mix__mha_block_cached__dense_activation_silu__decode'

def setup_inputs():

    _w = (lambda a: (lambda t: t.to(torch.bfloat16) if t.is_floating_point() else t)(torch.as_tensor(a)))
    def _A_setup():
        B, Sq, D = 2, 1, 640
        H, Sk, Dh = 32, 4096, 128
        return {
            "x": _w((lambda *s: torch.randn(*s, dtype=torch.bfloat16) * 0.05)(B, Sq, D)),
            "k_cache": _w((lambda *s: torch.randn(*s, dtype=torch.bfloat16) * 6.4)(B, H, Sk, Dh)),
            "v_cache": _w((lambda *s: torch.randn(*s, dtype=torch.bfloat16) * 0.2)(B, H, Sk, Dh)),
            "wq": _w((lambda *s: torch.randn(*s, dtype=torch.bfloat16) * 6.4)(D, H * Dh) * (D ** -0.5)),
            "wo": _w((lambda *s: torch.randn(*s, dtype=torch.bfloat16) * 0.2)(H * Dh, D) * ((H * Dh) ** -0.5)),
        }
    _A_in = _A_setup()

    def _B_setup():
        B, S, D, F = 2, 1, 640, 1728
        return {
            "x": _w((lambda *s: torch.randn(*s, dtype=torch.bfloat16) * 0.05)(B, S, D)),
            "w1": _w((lambda *s: torch.randn(*s, dtype=torch.bfloat16) * 6.4)(D, F) * (D ** -0.5)),
            "w2": _w((lambda *s: torch.randn(*s, dtype=torch.bfloat16) * 0.05)(F, D) * (F ** -0.5)),
        }
    _B_in = _B_setup()

    return {
        "A_x": _A_in["x"],
        "A_k_cache": _A_in["k_cache"],
        "A_v_cache": _A_in["v_cache"],
        "A_wq": _A_in["wq"],
        "A_wo": _A_in["wo"],
        "B_x": _B_in["x"],
        "B_w1": _B_in["w1"],
        "B_w2": _B_in["w2"],
        "gate_w": _w((lambda *s: torch.randn(*s, dtype=torch.bfloat16) * 0.05)(640) * 16.0),
    }

def reference(A_x, A_k_cache, A_v_cache, A_wq, A_wo, B_x, B_w1, B_w2, gate_w):
    def _A_ref(x, k_cache, v_cache, wq, wo):
        B, Sq, D = x.shape
        H, Dh = 32, 128
        q = (lambda x, *d: x.permute(*d))((x @ wq).reshape(B, Sq, H, Dh), 0, 2, 1, 3)
        scores = torch.einsum("bhqd,bhkd->bhqk", q, k_cache) * (Dh ** -0.5)
        p = _softmax(scores, axis=-1)
        o = torch.einsum("bhqk,bhkd->bhqd", p, v_cache)
        return (lambda x, *d: x.permute(*d))(o, 0, 2, 1, 3).reshape(B, Sq, H * Dh) @ wo

    def _B_ref(x, w1, w2):
        h = torch.einsum("bsd,df->bsf", x, w1)
        h = _silu(h)
        out = torch.einsum("bsf,fd->bsd", h, w2)
        return out

    x = A_x
    g = _sigmoid((x * gate_w).sum(-1, keepdims=True))
    a = _A_ref(x, A_k_cache, A_v_cache, A_wq, A_wo)
    b = _B_ref(x, B_w1, B_w2)
    return g * a + (1 - g) * b
```

```asm
; @launch kernel=gated_mix__mha_block_cached__dense_activation_silu__decode_k1_kernel grid=(256,1,1) block=(1024,1,1) lds=61952
; @launch kernel=gated_mix__mha_block_cached__dense_activation_silu__decode_k2_kernel grid=(40,1,1) block=(256,1,1) lds=4096
.amdgcn_target "amdgcn-amd-amdhsa--gfx950"
.text
.globl gated_mix__mha_block_cached__dense_activation_silu__decode_k1_kernel
.type gated_mix__mha_block_cached__dense_activation_silu__decode_k1_kernel,@function
.globl gated_mix__mha_block_cached__dense_activation_silu__decode_k2_kernel
.type gated_mix__mha_block_cached__dense_activation_silu__decode_k2_kernel,@function
.p2align 8
gated_mix__mha_block_cached__dense_activation_silu__decode_k1_kernel:
    s_cmp_ge_u32 s2, 256
    s_cbranch_scc1 Lk1_end
    s_load_dwordx16 s[16:31], s[0:1], 0
    s_load_dwordx2 s[32:33], s[0:1], 88
    v_lshrrev_b32 v2, 6, v0
    s_nop 0
    v_readfirstlane_b32 s69, v2
    s_and_b32 s3, s2, 31
    s_lshr_b32 s4, s2, 5
    s_and_b32 s5, s4, 1
    s_lshr_b32 s6, s4, 1
    s_mul_i32 s70, s69, 40
    s_lshl_b32 s71, s2, 5
    s_mul_i32 s72, s2, 20480
    s_lshl_b32 s73, s69, 14
    s_mov_b32 s74, 4096
    s_mov_b32 s75, 8192
    s_mov_b32 s76, 12288
    s_lshl_b32 s77, s5, 12
    s_lshl_b32 s78, s69, 9
    s_lshl_b32 s79, s69, 7
    s_mov_b32 s80, 0
    s_mov_b32 s81, 8192
    s_mov_b32 s82, 16384
    s_mov_b32 s83, 24576
    s_mov_b32 s84, 32768
    s_mov_b32 s85, 40960
    s_mov_b32 s86, 49152
    s_mov_b32 s87, 57344
    s_mov_b32 s88, 65536
    s_mov_b32 s89, 73728
    s_mul_i32 s90, s2, 5120
    s_add_u32 s90, s90, 2097152
    s_lshl_b32 s92, s2, 3
    s_add_u32 s92, s92, 1048576
    s_mul_i32 s93, s2, 2560
    s_waitcnt lgkmcnt(0)
    s_mov_b32 s36, s16
    s_and_b32 s37, s17, 0xffff
    s_mov_b32 s38, 2560
    s_mov_b32 s39, 0x00020000
    s_lshl_b32 s7, s5, 5
    s_add_u32 s7, s7, s3
    s_lshl_b32 s7, s7, 20
    s_lshl_b32 s8, s6, 18
    s_add_u32 s7, s7, s8
    s_add_u32 s10, s18, s7
    s_addc_u32 s11, s19, 0
    s_mov_b32 s40, s10
    s_and_b32 s41, s11, 0xffff
    s_mov_b32 s42, 262144
    s_mov_b32 s43, 0x00020000
    s_add_u32 s10, s20, s7
    s_addc_u32 s11, s21, 0
    s_mov_b32 s44, s10
    s_and_b32 s45, s11, 0xffff
    s_mov_b32 s46, 262144
    s_mov_b32 s47, 0x00020000
    s_lshl_b32 s7, s3, 8
    s_add_u32 s10, s22, s7
    s_addc_u32 s11, s23, 0
    s_sub_u32 s8, 5242880, s7
    s_mov_b32 s48, s10
    s_and_b32 s49, s11, 0xffff
    s_mov_b32 s50, s8
    s_mov_b32 s51, 0x00020000
    s_mul_i32 s7, s3, 163840
    s_add_u32 s10, s24, s7
    s_addc_u32 s11, s25, 0
    s_sub_u32 s8, 5242880, s7
    s_mov_b32 s52, s10
    s_and_b32 s53, s11, 0xffff
    s_mov_b32 s54, s8
    s_mov_b32 s55, 0x00020000
    s_mov_b32 s56, s28
    s_and_b32 s57, s29, 0xffff
    s_mov_b32 s58, 2211840
    s_mov_b32 s59, 0x00020000
    s_mov_b32 s60, s30
    s_and_b32 s61, s31, 0xffff
    s_mov_b32 s62, 2211840
    s_mov_b32 s63, 0x00020000
    s_mov_b32 s64, s32
    s_and_b32 s65, s33, 0xffff
    s_mov_b32 s66, 4194304
    s_mov_b32 s67, 0x00020000
    s_cmp_lt_u32 s2, 108
    s_cbranch_scc1 Lk1_ffn
    v_lshlrev_b32 v2, 1, v0
    buffer_load_ushort v16, v2, s[36:39], 0 offen
    buffer_load_ushort v17, v2, s[36:39], 0 offen offset:1280
    v_bfe_u32 v8, v0, 4, 2
    v_and_b32 v9, 15, v0
    v_mul_u32_u24 v3, 10, v8
    v_add_u32 v3, s70, v3
    v_lshlrev_b32 v3, 13, v3
    v_lshl_add_u32 v3, v9, 4, v3
    buffer_load_dwordx4 v[24:27], v3, s[48:51], s80 offen
    buffer_load_dwordx4 v[28:31], v3, s[48:51], s81 offen
    buffer_load_dwordx4 v[32:35], v3, s[48:51], s82 offen
    buffer_load_dwordx4 v[36:39], v3, s[48:51], s83 offen
    buffer_load_dwordx4 v[40:43], v3, s[48:51], s84 offen
    buffer_load_dwordx4 v[44:47], v3, s[48:51], s85 offen
    buffer_load_dwordx4 v[48:51], v3, s[48:51], s86 offen
    buffer_load_dwordx4 v[52:55], v3, s[48:51], s87 offen
    buffer_load_dwordx4 v[56:59], v3, s[48:51], s88 offen
    buffer_load_dwordx4 v[60:63], v3, s[48:51], s89 offen
    s_barrier
    v_lshlrev_b32 v1, 8, v8
    v_add_u32 v1, s73, v1
    v_lshl_add_u32 v1, v9, 4, v1
    buffer_load_dwordx4 v[64:67], v1, s[40:43], 0 offen offset:0 nt
    buffer_load_dwordx4 v[68:71], v1, s[40:43], 0 offen offset:1024 nt
    buffer_load_dwordx4 v[72:75], v1, s[40:43], 0 offen offset:2048 nt
    buffer_load_dwordx4 v[76:79], v1, s[40:43], 0 offen offset:3072 nt
    buffer_load_dwordx4 v[80:83], v1, s[40:43], s74 offen offset:0 nt
    buffer_load_dwordx4 v[84:87], v1, s[40:43], s74 offen offset:1024 nt
    buffer_load_dwordx4 v[88:91], v1, s[40:43], s74 offen offset:2048 nt
    buffer_load_dwordx4 v[92:95], v1, s[40:43], s74 offen offset:3072 nt
    buffer_load_dwordx4 v[96:99], v1, s[40:43], s75 offen offset:0 nt
    buffer_load_dwordx4 v[100:103], v1, s[40:43], s75 offen offset:1024 nt
    s_waitcnt vmcnt(20)
    v_lshlrev_b32 v16, 16, v16
    v_lshlrev_b32 v17, 16, v17
    v_lshlrev_b32 v2, 2, v0
    ds_write_b32 v2, v16 offset:0
    ds_write_b32 v2, v17 offset:4096
    s_waitcnt lgkmcnt(0)
    s_barrier
    v_mul_u32_u24 v2, 10, v8
    v_add_u32 v2, s70, v2
    v_lshlrev_b32 v2, 2, v2
    v_add_u32 v2, s77, v2
    v_mov_b32 v22, v8
    v_mov_b32 v23, v9
    v_mov_b32 v8, 0
    v_mov_b32 v9, 0
    v_mov_b32 v10, 0
    v_mov_b32 v11, 0
    v_mov_b32 v12, 0
    v_mov_b32 v13, 0
    v_mov_b32 v14, 0
    v_mov_b32 v15, 0
    ds_read_b64 v[16:17], v2 offset:0
    ds_read_b64 v[18:19], v2 offset:8
    ds_read_b32 v20, v2 offset:16
    s_waitcnt lgkmcnt(0)
    s_waitcnt vmcnt(19)
    v_lshlrev_b32 v21, 16, v24
    v_and_b32 v3, 0xffff0000, v24
    v_fmac_f32 v8, v16, v21
    v_fmac_f32 v9, v16, v3
    v_lshlrev_b32 v21, 16, v25
    v_and_b32 v3, 0xffff0000, v25
    v_fmac_f32 v10, v16, v21
    v_fmac_f32 v11, v16, v3
    v_lshlrev_b32 v21, 16, v26
    v_and_b32 v3, 0xffff0000, v26
    v_fmac_f32 v12, v16, v21
    v_fmac_f32 v13, v16, v3
    v_lshlrev_b32 v21, 16, v27
    v_and_b32 v3, 0xffff0000, v27
    v_fmac_f32 v14, v16, v21
    v_fmac_f32 v15, v16, v3
    s_waitcnt vmcnt(18)
    v_lshlrev_b32 v21, 16, v28
    v_and_b32 v3, 0xffff0000, v28
    v_fmac_f32 v8, v17, v21
    v_fmac_f32 v9, v17, v3
    v_lshlrev_b32 v21, 16, v29
    v_and_b32 v3, 0xffff0000, v29
    v_fmac_f32 v10, v17, v21
    v_fmac_f32 v11, v17, v3
    v_lshlrev_b32 v21, 16, v30
    v_and_b32 v3, 0xffff0000, v30
    v_fmac_f32 v12, v17, v21
    v_fmac_f32 v13, v17, v3
    v_lshlrev_b32 v21, 16, v31
    v_and_b32 v3, 0xffff0000, v31
    v_fmac_f32 v14, v17, v21
    v_fmac_f32 v15, v17, v3
    s_waitcnt vmcnt(17)
    v_lshlrev_b32 v21, 16, v32
    v_and_b32 v3, 0xffff0000, v32
    v_fmac_f32 v8, v18, v21
    v_fmac_f32 v9, v18, v3
    v_lshlrev_b32 v21, 16, v33
    v_and_b32 v3, 0xffff0000, v33
    v_fmac_f32 v10, v18, v21
    v_fmac_f32 v11, v18, v3
    v_lshlrev_b32 v21, 16, v34
    v_and_b32 v3, 0xffff0000, v34
    v_fmac_f32 v12, v18, v21
    v_fmac_f32 v13, v18, v3
    v_lshlrev_b32 v21, 16, v35
    v_and_b32 v3, 0xffff0000, v35
    v_fmac_f32 v14, v18, v21
    v_fmac_f32 v15, v18, v3
    s_waitcnt vmcnt(16)
    v_lshlrev_b32 v21, 16, v36
    v_and_b32 v3, 0xffff0000, v36
    v_fmac_f32 v8, v19, v21
    v_fmac_f32 v9, v19, v3
    v_lshlrev_b32 v21, 16, v37
    v_and_b32 v3, 0xffff0000, v37
    v_fmac_f32 v10, v19, v21
    v_fmac_f32 v11, v19, v3
    v_lshlrev_b32 v21, 16, v38
    v_and_b32 v3, 0xffff0000, v38
    v_fmac_f32 v12, v19, v21
    v_fmac_f32 v13, v19, v3
    v_lshlrev_b32 v21, 16, v39
    v_and_b32 v3, 0xffff0000, v39
    v_fmac_f32 v14, v19, v21
    v_fmac_f32 v15, v19, v3
    s_waitcnt vmcnt(15)
    v_lshlrev_b32 v21, 16, v40
    v_and_b32 v3, 0xffff0000, v40
    v_fmac_f32 v8, v20, v21
    v_fmac_f32 v9, v20, v3
    v_lshlrev_b32 v21, 16, v41
    v_and_b32 v3, 0xffff0000, v41
    v_fmac_f32 v10, v20, v21
    v_fmac_f32 v11, v20, v3
    v_lshlrev_b32 v21, 16, v42
    v_and_b32 v3, 0xffff0000, v42
    v_fmac_f32 v12, v20, v21
    v_fmac_f32 v13, v20, v3
    v_lshlrev_b32 v21, 16, v43
    v_and_b32 v3, 0xffff0000, v43
    v_fmac_f32 v14, v20, v21
    v_fmac_f32 v15, v20, v3
    ds_read_b64 v[16:17], v2 offset:20
    ds_read_b64 v[18:19], v2 offset:28
    ds_read_b32 v20, v2 offset:36
    s_waitcnt lgkmcnt(0)
    s_waitcnt vmcnt(14)
    v_lshlrev_b32 v21, 16, v44
    v_and_b32 v3, 0xffff0000, v44
    v_fmac_f32 v8, v16, v21
    v_fmac_f32 v9, v16, v3
    v_lshlrev_b32 v21, 16, v45
    v_and_b32 v3, 0xffff0000, v45
    v_fmac_f32 v10, v16, v21
    v_fmac_f32 v11, v16, v3
    v_lshlrev_b32 v21, 16, v46
    v_and_b32 v3, 0xffff0000, v46
    v_fmac_f32 v12, v16, v21
    v_fmac_f32 v13, v16, v3
    v_lshlrev_b32 v21, 16, v47
    v_and_b32 v3, 0xffff0000, v47
    v_fmac_f32 v14, v16, v21
    v_fmac_f32 v15, v16, v3
    s_waitcnt vmcnt(13)
    v_lshlrev_b32 v21, 16, v48
    v_and_b32 v3, 0xffff0000, v48
    v_fmac_f32 v8, v17, v21
    v_fmac_f32 v9, v17, v3
    v_lshlrev_b32 v21, 16, v49
    v_and_b32 v3, 0xffff0000, v49
    v_fmac_f32 v10, v17, v21
    v_fmac_f32 v11, v17, v3
    v_lshlrev_b32 v21, 16, v50
    v_and_b32 v3, 0xffff0000, v50
    v_fmac_f32 v12, v17, v21
    v_fmac_f32 v13, v17, v3
    v_lshlrev_b32 v21, 16, v51
    v_and_b32 v3, 0xffff0000, v51
    v_fmac_f32 v14, v17, v21
    v_fmac_f32 v15, v17, v3
    s_waitcnt vmcnt(12)
    v_lshlrev_b32 v21, 16, v52
    v_and_b32 v3, 0xffff0000, v52
    v_fmac_f32 v8, v18, v21
    v_fmac_f32 v9, v18, v3
    v_lshlrev_b32 v21, 16, v53
    v_and_b32 v3, 0xffff0000, v53
    v_fmac_f32 v10, v18, v21
    v_fmac_f32 v11, v18, v3
    v_lshlrev_b32 v21, 16, v54
    v_and_b32 v3, 0xffff0000, v54
    v_fmac_f32 v12, v18, v21
    v_fmac_f32 v13, v18, v3
    v_lshlrev_b32 v21, 16, v55
    v_and_b32 v3, 0xffff0000, v55
    v_fmac_f32 v14, v18, v21
    v_fmac_f32 v15, v18, v3
    s_waitcnt vmcnt(11)
    v_lshlrev_b32 v21, 16, v56
    v_and_b32 v3, 0xffff0000, v56
    v_fmac_f32 v8, v19, v21
    v_fmac_f32 v9, v19, v3
    v_lshlrev_b32 v21, 16, v57
    v_and_b32 v3, 0xffff0000, v57
    v_fmac_f32 v10, v19, v21
    v_fmac_f32 v11, v19, v3
    v_lshlrev_b32 v21, 16, v58
    v_and_b32 v3, 0xffff0000, v58
    v_fmac_f32 v12, v19, v21
    v_fmac_f32 v13, v19, v3
    v_lshlrev_b32 v21, 16, v59
    v_and_b32 v3, 0xffff0000, v59
    v_fmac_f32 v14, v19, v21
    v_fmac_f32 v15, v19, v3
    s_waitcnt vmcnt(10)
    v_lshlrev_b32 v21, 16, v60
    v_and_b32 v3, 0xffff0000, v60
    v_fmac_f32 v8, v20, v21
    v_fmac_f32 v9, v20, v3
    v_lshlrev_b32 v21, 16, v61
    v_and_b32 v3, 0xffff0000, v61
    v_fmac_f32 v10, v20, v21
    v_fmac_f32 v11, v20, v3
    v_lshlrev_b32 v21, 16, v62
    v_and_b32 v3, 0xffff0000, v62
    v_fmac_f32 v12, v20, v21
    v_fmac_f32 v13, v20, v3
    v_lshlrev_b32 v21, 16, v63
    v_and_b32 v3, 0xffff0000, v63
    v_fmac_f32 v14, v20, v21
    v_fmac_f32 v15, v20, v3
    v_mov_b32 v16, v8
    v_mov_b32 v17, v9
    v_mov_b32 v18, v10
    v_mov_b32 v19, v11
    v_mov_b32 v20, v12
    v_mov_b32 v21, v13
    v_mov_b32 v2, v14
    v_mov_b32 v3, v15
    s_nop 1
    v_permlane16_swap_b32 v8, v16
    v_permlane16_swap_b32 v9, v17
    v_permlane16_swap_b32 v10, v18
    v_permlane16_swap_b32 v11, v19
    v_permlane16_swap_b32 v12, v20
    v_permlane16_swap_b32 v13, v21
    v_permlane16_swap_b32 v14, v2
    v_permlane16_swap_b32 v15, v3
    v_add_f32 v8, v8, v16
    v_add_f32 v9, v9, v17
    v_add_f32 v10, v10, v18
    v_add_f32 v11, v11, v19
    v_add_f32 v12, v12, v20
    v_add_f32 v13, v13, v21
    v_add_f32 v14, v14, v2
    v_add_f32 v15, v15, v3
    v_mov_b32 v16, v8
    v_mov_b32 v17, v9
    v_mov_b32 v18, v10
    v_mov_b32 v19, v11
    v_mov_b32 v20, v12
    v_mov_b32 v21, v13
    v_mov_b32 v2, v14
    v_mov_b32 v3, v15
    s_nop 1
    v_permlane32_swap_b32 v8, v16
    v_permlane32_swap_b32 v9, v17
    v_permlane32_swap_b32 v10, v18
    v_permlane32_swap_b32 v11, v19
    v_permlane32_swap_b32 v12, v20
    v_permlane32_swap_b32 v13, v21
    v_permlane32_swap_b32 v14, v2
    v_permlane32_swap_b32 v15, v3
    v_add_f32 v8, v8, v16
    v_add_f32 v9, v9, v17
    v_add_f32 v10, v10, v18
    v_add_f32 v11, v11, v19
    v_add_f32 v12, v12, v20
    v_add_f32 v13, v13, v21
    v_add_f32 v14, v14, v2
    v_add_f32 v15, v15, v3
    v_lshlrev_b32 v2, 5, v23
    v_add_u32 v2, s78, v2
    ds_write_b128 v2, v[8:11] offset:8192
    ds_write_b128 v2, v[12:15] offset:8208
    s_waitcnt lgkmcnt(0)
    s_barrier
    s_cmp_ge_u32 s69, 2
    s_cbranch_scc1 Lq0_a
    v_lshlrev_b32 v2, 2, v0
    ds_read_b32 v8, v2 offset:8192
    ds_read_b32 v9, v2 offset:8704
    ds_read_b32 v10, v2 offset:9216
    ds_read_b32 v11, v2 offset:9728
    ds_read_b32 v12, v2 offset:10240
    ds_read_b32 v13, v2 offset:10752
    ds_read_b32 v14, v2 offset:11264
    ds_read_b32 v15, v2 offset:11776
    ds_read_b32 v16, v2 offset:12288
    ds_read_b32 v17, v2 offset:12800
    ds_read_b32 v18, v2 offset:13312
    ds_read_b32 v19, v2 offset:13824
    ds_read_b32 v20, v2 offset:14336
    ds_read_b32 v21, v2 offset:14848
    s_waitcnt lgkmcnt(0)
    v_add_f32 v8, v8, v9
    v_add_f32 v8, v8, v10
    v_add_f32 v8, v8, v11
    v_add_f32 v8, v8, v12
    v_add_f32 v8, v8, v13
    v_add_f32 v8, v8, v14
    v_add_f32 v8, v8, v15
    v_add_f32 v8, v8, v16
    v_add_f32 v8, v8, v17
    v_add_f32 v8, v8, v18
    v_add_f32 v8, v8, v19
    v_add_f32 v8, v8, v20
    v_add_f32 v8, v8, v21
    ds_read_b32 v9, v2 offset:15360
    ds_read_b32 v10, v2 offset:15872
    s_waitcnt lgkmcnt(0)
    v_add_f32 v8, v8, v9
    v_add_f32 v8, v8, v10
    v_cvt_pk_bf16_f32 v8, v8, v8
    v_lshlrev_b32 v2, 1, v0
    ds_write_b16 v2, v8 offset:16384
    s_branch Lq0_b
Lq0_a:
Lq0_b:
    s_waitcnt lgkmcnt(0)
    s_barrier
    v_lshlrev_b32 v2, 4, v23
    ds_read_b128 v[4:7], v2 offset:16384
    s_waitcnt lgkmcnt(0)
    buffer_load_dwordx4 v[104:107], v1, s[40:43], s75 offen offset:2048 nt
    buffer_load_dwordx4 v[108:111], v1, s[40:43], s75 offen offset:3072 nt
    buffer_load_dwordx4 v[112:115], v1, s[40:43], s76 offen offset:0 nt
    buffer_load_dwordx4 v[116:119], v1, s[40:43], s76 offen offset:1024 nt
    buffer_load_dwordx4 v[120:123], v1, s[40:43], s76 offen offset:2048 nt
    buffer_load_dwordx4 v[124:127], v1, s[40:43], s76 offen offset:3072 nt
    buffer_load_dwordx4 v[24:27], v1, s[44:47], 0 offen offset:0 nt
    buffer_load_dwordx4 v[28:31], v1, s[44:47], 0 offen offset:1024 nt
    buffer_load_dwordx4 v[32:35], v1, s[44:47], 0 offen offset:2048 nt
    buffer_load_dwordx4 v[36:39], v1, s[44:47], 0 offen offset:3072 nt
    s_waitcnt vmcnt(16)
    v_dot2_f32_bf16 v40, v64, v4, 0
    v_dot2_f32_bf16 v41, v68, v4, 0
    v_dot2_f32_bf16 v42, v72, v4, 0
    v_dot2_f32_bf16 v43, v76, v4, 0
    v_dot2_f32_bf16 v40, v65, v5, v40
    v_dot2_f32_bf16 v41, v69, v5, v41
    v_dot2_f32_bf16 v42, v73, v5, v42
    v_dot2_f32_bf16 v43, v77, v5, v43
    v_dot2_f32_bf16 v40, v66, v6, v40
    v_dot2_f32_bf16 v41, v70, v6, v41
    v_dot2_f32_bf16 v42, v74, v6, v42
    v_dot2_f32_bf16 v43, v78, v6, v43
    v_dot2_f32_bf16 v40, v67, v7, v40
    v_dot2_f32_bf16 v41, v71, v7, v41
    v_dot2_f32_bf16 v42, v75, v7, v42
    v_dot2_f32_bf16 v43, v79, v7, v43
    s_nop 2
    v_add_f32_dpp v40, v40, v40 row_ror:8 row_mask:0xf bank_mask:0xf
    v_add_f32_dpp v41, v41, v41 row_ror:8 row_mask:0xf bank_mask:0xf
    v_add_f32_dpp v42, v42, v42 row_ror:8 row_mask:0xf bank_mask:0xf
    v_add_f32_dpp v43, v43, v43 row_ror:8 row_mask:0xf bank_mask:0xf
    s_nop 0
    v_add_f32_dpp v40, v40, v40 row_ror:4 row_mask:0xf bank_mask:0xf
    v_add_f32_dpp v41, v41, v41 row_ror:4 row_mask:0xf bank_mask:0xf
    v_add_f32_dpp v42, v42, v42 row_ror:4 row_mask:0xf bank_mask:0xf
    v_add_f32_dpp v43, v43, v43 row_ror:4 row_mask:0xf bank_mask:0xf
    s_nop 0
    v_add_f32_dpp v40, v40, v40 row_ror:2 row_mask:0xf bank_mask:0xf
    v_add_f32_dpp v41, v41, v41 row_ror:2 row_mask:0xf bank_mask:0xf
    v_add_f32_dpp v42, v42, v42 row_ror:2 row_mask:0xf bank_mask:0xf
    v_add_f32_dpp v43, v43, v43 row_ror:2 row_mask:0xf bank_mask:0xf
    s_nop 0
    v_add_f32_dpp v40, v40, v40 row_ror:1 row_mask:0xf bank_mask:0xf
    v_add_f32_dpp v41, v41, v41 row_ror:1 row_mask:0xf bank_mask:0xf
    v_add_f32_dpp v42, v42, v42 row_ror:1 row_mask:0xf bank_mask:0xf
    v_add_f32_dpp v43, v43, v43 row_ror:1 row_mask:0xf bank_mask:0xf
    s_waitcnt vmcnt(12)
    v_dot2_f32_bf16 v44, v80, v4, 0
    v_dot2_f32_bf16 v45, v84, v4, 0
    v_dot2_f32_bf16 v46, v88, v4, 0
    v_dot2_f32_bf16 v47, v92, v4, 0
    v_dot2_f32_bf16 v44, v81, v5, v44
    v_dot2_f32_bf16 v45, v85, v5, v45
    v_dot2_f32_bf16 v46, v89, v5, v46
    v_dot2_f32_bf16 v47, v93, v5, v47
    v_dot2_f32_bf16 v44, v82, v6, v44
    v_dot2_f32_bf16 v45, v86, v6, v45
    v_dot2_f32_bf16 v46, v90, v6, v46
    v_dot2_f32_bf16 v47, v94, v6, v47
    v_dot2_f32_bf16 v44, v83, v7, v44
    v_dot2_f32_bf16 v45, v87, v7, v45
    v_dot2_f32_bf16 v46, v91, v7, v46
    v_dot2_f32_bf16 v47, v95, v7, v47
    s_nop 2
    v_add_f32_dpp v44, v44, v44 row_ror:8 row_mask:0xf bank_mask:0xf
    v_add_f32_dpp v45, v45, v45 row_ror:8 row_mask:0xf bank_mask:0xf
    v_add_f32_dpp v46, v46, v46 row_ror:8 row_mask:0xf bank_mask:0xf
    v_add_f32_dpp v47, v47, v47 row_ror:8 row_mask:0xf bank_mask:0xf
    s_nop 0
    v_add_f32_dpp v44, v44, v44 row_ror:4 row_mask:0xf bank_mask:0xf
    v_add_f32_dpp v45, v45, v45 row_ror:4 row_mask:0xf bank_mask:0xf
    v_add_f32_dpp v46, v46, v46 row_ror:4 row_mask:0xf bank_mask:0xf
    v_add_f32_dpp v47, v47, v47 row_ror:4 row_mask:0xf bank_mask:0xf
    s_nop 0
    v_add_f32_dpp v44, v44, v44 row_ror:2 row_mask:0xf bank_mask:0xf
    v_add_f32_dpp v45, v45, v45 row_ror:2 row_mask:0xf bank_mask:0xf
    v_add_f32_dpp v46, v46, v46 row_ror:2 row_mask:0xf bank_mask:0xf
    v_add_f32_dpp v47, v47, v47 row_ror:2 row_mask:0xf bank_mask:0xf
    s_nop 0
    v_add_f32_dpp v44, v44, v44 row_ror:1 row_mask:0xf bank_mask:0xf
    v_add_f32_dpp v45, v45, v45 row_ror:1 row_mask:0xf bank_mask:0xf
    v_add_f32_dpp v46, v46, v46 row_ror:1 row_mask:0xf bank_mask:0xf
    v_add_f32_dpp v47, v47, v47 row_ror:1 row_mask:0xf bank_mask:0xf
    s_waitcnt vmcnt(8)
    v_dot2_f32_bf16 v48, v96, v4, 0
    v_dot2_f32_bf16 v49, v100, v4, 0
    v_dot2_f32_bf16 v50, v104, v4, 0
    v_dot2_f32_bf16 v51, v108, v4, 0
    v_dot2_f32_bf16 v48, v97, v5, v48
    v_dot2_f32_bf16 v49, v101, v5, v49
    v_dot2_f32_bf16 v50, v105, v5, v50
    v_dot2_f32_bf16 v51, v109, v5, v51
    v_dot2_f32_bf16 v48, v98, v6, v48
    v_dot2_f32_bf16 v49, v102, v6, v49
    v_dot2_f32_bf16 v50, v106, v6, v50
    v_dot2_f32_bf16 v51, v110, v6, v51
    v_dot2_f32_bf16 v48, v99, v7, v48
    v_dot2_f32_bf16 v49, v103, v7, v49
    v_dot2_f32_bf16 v50, v107, v7, v50
    v_dot2_f32_bf16 v51, v111, v7, v51
    s_nop 2
    v_add_f32_dpp v48, v48, v48 row_ror:8 row_mask:0xf bank_mask:0xf
    v_add_f32_dpp v49, v49, v49 row_ror:8 row_mask:0xf bank_mask:0xf
    v_add_f32_dpp v50, v50, v50 row_ror:8 row_mask:0xf bank_mask:0xf
    v_add_f32_dpp v51, v51, v51 row_ror:8 row_mask:0xf bank_mask:0xf
    s_nop 0
    v_add_f32_dpp v48, v48, v48 row_ror:4 row_mask:0xf bank_mask:0xf
    v_add_f32_dpp v49, v49, v49 row_ror:4 row_mask:0xf bank_mask:0xf
    v_add_f32_dpp v50, v50, v50 row_ror:4 row_mask:0xf bank_mask:0xf
    v_add_f32_dpp v51, v51, v51 row_ror:4 row_mask:0xf bank_mask:0xf
    s_nop 0
    v_add_f32_dpp v48, v48, v48 row_ror:2 row_mask:0xf bank_mask:0xf
    v_add_f32_dpp v49, v49, v49 row_ror:2 row_mask:0xf bank_mask:0xf
    v_add_f32_dpp v50, v50, v50 row_ror:2 row_mask:0xf bank_mask:0xf
    v_add_f32_dpp v51, v51, v51 row_ror:2 row_mask:0xf bank_mask:0xf
    s_nop 0
    v_add_f32_dpp v48, v48, v48 row_ror:1 row_mask:0xf bank_mask:0xf
    v_add_f32_dpp v49, v49, v49 row_ror:1 row_mask:0xf bank_mask:0xf
    v_add_f32_dpp v50, v50, v50 row_ror:1 row_mask:0xf bank_mask:0xf
    v_add_f32_dpp v51, v51, v51 row_ror:1 row_mask:0xf bank_mask:0xf
    s_waitcnt vmcnt(4)
    v_dot2_f32_bf16 v52, v112, v4, 0
    v_dot2_f32_bf16 v53, v116, v4, 0
    v_dot2_f32_bf16 v54, v120, v4, 0
    v_dot2_f32_bf16 v55, v124, v4, 0
    v_dot2_f32_bf16 v52, v113, v5, v52
    v_dot2_f32_bf16 v53, v117, v5, v53
    v_dot2_f32_bf16 v54, v121, v5, v54
    v_dot2_f32_bf16 v55, v125, v5, v55
    v_dot2_f32_bf16 v52, v114, v6, v52
    v_dot2_f32_bf16 v53, v118, v6, v53
    v_dot2_f32_bf16 v54, v122, v6, v54
    v_dot2_f32_bf16 v55, v126, v6, v55
    v_dot2_f32_bf16 v52, v115, v7, v52
    v_dot2_f32_bf16 v53, v119, v7, v53
    v_dot2_f32_bf16 v54, v123, v7, v54
    v_dot2_f32_bf16 v55, v127, v7, v55
    s_nop 2
    v_add_f32_dpp v52, v52, v52 row_ror:8 row_mask:0xf bank_mask:0xf
    v_add_f32_dpp v53, v53, v53 row_ror:8 row_mask:0xf bank_mask:0xf
    v_add_f32_dpp v54, v54, v54 row_ror:8 row_mask:0xf bank_mask:0xf
    v_add_f32_dpp v55, v55, v55 row_ror:8 row_mask:0xf bank_mask:0xf
    s_nop 0
    v_add_f32_dpp v52, v52, v52 row_ror:4 row_mask:0xf bank_mask:0xf
    v_add_f32_dpp v53, v53, v53 row_ror:4 row_mask:0xf bank_mask:0xf
    v_add_f32_dpp v54, v54, v54 row_ror:4 row_mask:0xf bank_mask:0xf
    v_add_f32_dpp v55, v55, v55 row_ror:4 row_mask:0xf bank_mask:0xf
    s_nop 0
    v_add_f32_dpp v52, v52, v52 row_ror:2 row_mask:0xf bank_mask:0xf
    v_add_f32_dpp v53, v53, v53 row_ror:2 row_mask:0xf bank_mask:0xf
    v_add_f32_dpp v54, v54, v54 row_ror:2 row_mask:0xf bank_mask:0xf
    v_add_f32_dpp v55, v55, v55 row_ror:2 row_mask:0xf bank_mask:0xf
    s_nop 0
    v_add_f32_dpp v52, v52, v52 row_ror:1 row_mask:0xf bank_mask:0xf
    v_add_f32_dpp v53, v53, v53 row_ror:1 row_mask:0xf bank_mask:0xf
    v_add_f32_dpp v54, v54, v54 row_ror:1 row_mask:0xf bank_mask:0xf
    v_add_f32_dpp v55, v55, v55 row_ror:1 row_mask:0xf bank_mask:0xf
    buffer_load_dwordx4 v[64:67], v1, s[44:47], s74 offen offset:0 nt
    buffer_load_dwordx4 v[68:71], v1, s[44:47], s74 offen offset:1024 nt
    buffer_load_dwordx4 v[72:75], v1, s[44:47], s74 offen offset:2048 nt
    buffer_load_dwordx4 v[76:79], v1, s[44:47], s74 offen offset:3072 nt
    buffer_load_dwordx4 v[80:83], v1, s[44:47], s75 offen offset:0 nt
    buffer_load_dwordx4 v[84:87], v1, s[44:47], s75 offen offset:1024 nt
    buffer_load_dwordx4 v[88:91], v1, s[44:47], s75 offen offset:2048 nt
    buffer_load_dwordx4 v[92:95], v1, s[44:47], s75 offen offset:3072 nt
    buffer_load_dwordx4 v[96:99], v1, s[44:47], s76 offen offset:0 nt
    buffer_load_dwordx4 v[100:103], v1, s[44:47], s76 offen offset:1024 nt
    buffer_load_dwordx4 v[104:107], v1, s[44:47], s76 offen offset:2048 nt
    buffer_load_dwordx4 v[108:111], v1, s[44:47], s76 offen offset:3072 nt
    v_mov_b32 v3, 52429
    v_mul_u32_u24 v2, v0, v3
    v_lshrrev_b32 v22, 22, v2
    v_mul_u32_u24 v3, 80, v22
    v_sub_u32 v23, v0, v3
    v_mov_b32 v3, 1280
    v_mul_u32_u24 v21, v22, v3
    v_lshl_add_u32 v21, v23, 4, v21
    v_add_u32 v2, 0, v21
    buffer_load_dwordx4 v[112:115], v2, s[52:55], 0 offen
    v_add_u32 v2, 15360, v21
    buffer_load_dwordx4 v[116:119], v2, s[52:55], 0 offen
    v_add_u32 v2, 30720, v21
    buffer_load_dwordx4 v[120:123], v2, s[52:55], 0 offen
    v_add_u32 v2, 46080, v21
    buffer_load_dwordx4 v[124:127], v2, s[52:55], 0 offen
    v_cvt_pk_bf16_f32 v2, v40, v41
    v_lshlrev_b32 v40, 16, v2
    v_and_b32 v41, 0xffff0000, v2
    v_cvt_pk_bf16_f32 v2, v42, v43
    v_lshlrev_b32 v42, 16, v2
    v_and_b32 v43, 0xffff0000, v2
    v_cvt_pk_bf16_f32 v2, v44, v45
    v_lshlrev_b32 v44, 16, v2
    v_and_b32 v45, 0xffff0000, v2
    v_cvt_pk_bf16_f32 v2, v46, v47
    v_lshlrev_b32 v46, 16, v2
    v_and_b32 v47, 0xffff0000, v2
    v_cvt_pk_bf16_f32 v2, v48, v49
    v_lshlrev_b32 v48, 16, v2
    v_and_b32 v49, 0xffff0000, v2
    v_cvt_pk_bf16_f32 v2, v50, v51
    v_lshlrev_b32 v50, 16, v2
    v_and_b32 v51, 0xffff0000, v2
    v_cvt_pk_bf16_f32 v2, v52, v53
    v_lshlrev_b32 v52, 16, v2
    v_and_b32 v53, 0xffff0000, v2
    v_cvt_pk_bf16_f32 v2, v54, v55
    v_lshlrev_b32 v54, 16, v2
    v_and_b32 v55, 0xffff0000, v2
    v_mul_f32 v40, 0x3db504f3, v40
    v_mul_f32 v41, 0x3db504f3, v41
    v_mul_f32 v42, 0x3db504f3, v42
    v_mul_f32 v43, 0x3db504f3, v43
    v_mul_f32 v44, 0x3db504f3, v44
    v_mul_f32 v45, 0x3db504f3, v45
    v_mul_f32 v46, 0x3db504f3, v46
    v_mul_f32 v47, 0x3db504f3, v47
    v_mul_f32 v48, 0x3db504f3, v48
    v_mul_f32 v49, 0x3db504f3, v49
    v_mul_f32 v50, 0x3db504f3, v50
    v_mul_f32 v51, 0x3db504f3, v51
    v_mul_f32 v52, 0x3db504f3, v52
    v_mul_f32 v53, 0x3db504f3, v53
    v_mul_f32 v54, 0x3db504f3, v54
    v_mul_f32 v55, 0x3db504f3, v55
    v_cvt_pk_bf16_f32 v2, v40, v41
    v_lshlrev_b32 v40, 16, v2
    v_and_b32 v41, 0xffff0000, v2
    v_cvt_pk_bf16_f32 v2, v42, v43
    v_lshlrev_b32 v42, 16, v2
    v_and_b32 v43, 0xffff0000, v2
    v_cvt_pk_bf16_f32 v2, v44, v45
    v_lshlrev_b32 v44, 16, v2
    v_and_b32 v45, 0xffff0000, v2
    v_cvt_pk_bf16_f32 v2, v46, v47
    v_lshlrev_b32 v46, 16, v2
    v_and_b32 v47, 0xffff0000, v2
    v_cvt_pk_bf16_f32 v2, v48, v49
    v_lshlrev_b32 v48, 16, v2
    v_and_b32 v49, 0xffff0000, v2
    v_cvt_pk_bf16_f32 v2, v50, v51
    v_lshlrev_b32 v50, 16, v2
    v_and_b32 v51, 0xffff0000, v2
    v_cvt_pk_bf16_f32 v2, v52, v53
    v_lshlrev_b32 v52, 16, v2
    v_and_b32 v53, 0xffff0000, v2
    v_cvt_pk_bf16_f32 v2, v54, v55
    v_lshlrev_b32 v54, 16, v2
    v_and_b32 v55, 0xffff0000, v2
    v_max3_f32 v16, v40, v41, v42
    v_max3_f32 v16, v16, v43, v44
    v_max3_f32 v16, v16, v45, v46
    v_max3_f32 v16, v16, v47, v48
    v_max3_f32 v16, v16, v49, v50
    v_max3_f32 v16, v16, v51, v52
    v_max3_f32 v16, v16, v53, v54
    v_max_f32 v16, v16, v55
    v_mul_f32 v17, 0xbfb8aa3b, v16
    s_mov_b32 s91, 0x3fb8aa3b
    v_fma_f32 v40, v40, s91, v17
    v_fma_f32 v41, v41, s91, v17
    v_fma_f32 v42, v42, s91, v17
    v_fma_f32 v43, v43, s91, v17
    v_fma_f32 v44, v44, s91, v17
    v_fma_f32 v45, v45, s91, v17
    v_fma_f32 v46, v46, s91, v17
    v_fma_f32 v47, v47, s91, v17
    v_fma_f32 v48, v48, s91, v17
    v_fma_f32 v49, v49, s91, v17
    v_fma_f32 v50, v50, s91, v17
    v_fma_f32 v51, v51, s91, v17
    v_fma_f32 v52, v52, s91, v17
    v_fma_f32 v53, v53, s91, v17
    v_fma_f32 v54, v54, s91, v17
    v_fma_f32 v55, v55, s91, v17
    v_exp_f32 v40, v40
    v_exp_f32 v41, v41
    v_exp_f32 v42, v42
    v_exp_f32 v43, v43
    v_exp_f32 v44, v44
    v_exp_f32 v45, v45
    v_exp_f32 v46, v46
    v_exp_f32 v47, v47
    v_exp_f32 v48, v48
    v_exp_f32 v49, v49
    v_exp_f32 v50, v50
    v_exp_f32 v51, v51
    v_exp_f32 v52, v52
    v_exp_f32 v53, v53
    v_exp_f32 v54, v54
    v_exp_f32 v55, v55
    s_nop 0
    v_add_f32 v18, v40, v41
    v_add_f32 v18, v18, v42
    v_add_f32 v18, v18, v43
    v_add_f32 v18, v18, v44
    v_add_f32 v18, v18, v45
    v_add_f32 v18, v18, v46
    v_add_f32 v18, v18, v47
    v_add_f32 v18, v18, v48
    v_add_f32 v18, v18, v49
    v_add_f32 v18, v18, v50
    v_add_f32 v18, v18, v51
    v_add_f32 v18, v18, v52
    v_add_f32 v18, v18, v53
    v_add_f32 v18, v18, v54
    v_add_f32 v18, v18, v55
    v_mov_b32 v56, 0
    v_mov_b32 v57, 0
    v_mov_b32 v58, 0
    v_mov_b32 v59, 0
    v_mov_b32 v60, 0
    v_mov_b32 v61, 0
    v_mov_b32 v62, 0
    v_mov_b32 v63, 0
    s_waitcnt vmcnt(19)
    v_lshlrev_b32 v19, 16, v24
    v_and_b32 v20, 0xffff0000, v24
    v_fmac_f32 v56, v40, v19
    v_fmac_f32 v57, v40, v20
    v_lshlrev_b32 v19, 16, v25
    v_and_b32 v20, 0xffff0000, v25
    v_fmac_f32 v58, v40, v19
    v_fmac_f32 v59, v40, v20
    v_lshlrev_b32 v19, 16, v26
    v_and_b32 v20, 0xffff0000, v26
    v_fmac_f32 v60, v40, v19
    v_fmac_f32 v61, v40, v20
    v_lshlrev_b32 v19, 16, v27
    v_and_b32 v20, 0xffff0000, v27
    v_fmac_f32 v62, v40, v19
    v_fmac_f32 v63, v40, v20
    v_add_u32 v2, 61440, v21
    buffer_load_dwordx4 v[24:27], v2, s[52:55], 0 offen
    s_waitcnt vmcnt(19)
    v_lshlrev_b32 v19, 16, v28
    v_and_b32 v20, 0xffff0000, v28
    v_fmac_f32 v56, v41, v19
    v_fmac_f32 v57, v41, v20
    v_lshlrev_b32 v19, 16, v29
    v_and_b32 v20, 0xffff0000, v29
    v_fmac_f32 v58, v41, v19
    v_fmac_f32 v59, v41, v20
    v_lshlrev_b32 v19, 16, v30
    v_and_b32 v20, 0xffff0000, v30
    v_fmac_f32 v60, v41, v19
    v_fmac_f32 v61, v41, v20
    v_lshlrev_b32 v19, 16, v31
    v_and_b32 v20, 0xffff0000, v31
    v_fmac_f32 v62, v41, v19
    v_fmac_f32 v63, v41, v20
    v_add_u32 v2, 76800, v21
    buffer_load_dwordx4 v[28:31], v2, s[52:55], 0 offen
    s_waitcnt vmcnt(19)
    v_lshlrev_b32 v19, 16, v32
    v_and_b32 v20, 0xffff0000, v32
    v_fmac_f32 v56, v42, v19
    v_fmac_f32 v57, v42, v20
    v_lshlrev_b32 v19, 16, v33
    v_and_b32 v20, 0xffff0000, v33
    v_fmac_f32 v58, v42, v19
    v_fmac_f32 v59, v42, v20
    v_lshlrev_b32 v19, 16, v34
    v_and_b32 v20, 0xffff0000, v34
    v_fmac_f32 v60, v42, v19
    v_fmac_f32 v61, v42, v20
    v_lshlrev_b32 v19, 16, v35
    v_and_b32 v20, 0xffff0000, v35
    v_fmac_f32 v62, v42, v19
    v_fmac_f32 v63, v42, v20
    v_add_u32 v2, 92160, v21
    buffer_load_dwordx4 v[32:35], v2, s[52:55], 0 offen
    s_waitcnt vmcnt(19)
    v_lshlrev_b32 v19, 16, v36
    v_and_b32 v20, 0xffff0000, v36
    v_fmac_f32 v56, v43, v19
    v_fmac_f32 v57, v43, v20
    v_lshlrev_b32 v19, 16, v37
    v_and_b32 v20, 0xffff0000, v37
    v_fmac_f32 v58, v43, v19
    v_fmac_f32 v59, v43, v20
    v_lshlrev_b32 v19, 16, v38
    v_and_b32 v20, 0xffff0000, v38
    v_fmac_f32 v60, v43, v19
    v_fmac_f32 v61, v43, v20
    v_lshlrev_b32 v19, 16, v39
    v_and_b32 v20, 0xffff0000, v39
    v_fmac_f32 v62, v43, v19
    v_fmac_f32 v63, v43, v20
    v_add_u32 v2, 107520, v21
    buffer_load_dwordx4 v[36:39], v2, s[52:55], 0 offen
    s_waitcnt vmcnt(19)
    v_lshlrev_b32 v19, 16, v64
    v_and_b32 v20, 0xffff0000, v64
    v_fmac_f32 v56, v44, v19
    v_fmac_f32 v57, v44, v20
    v_lshlrev_b32 v19, 16, v65
    v_and_b32 v20, 0xffff0000, v65
    v_fmac_f32 v58, v44, v19
    v_fmac_f32 v59, v44, v20
    v_lshlrev_b32 v19, 16, v66
    v_and_b32 v20, 0xffff0000, v66
    v_fmac_f32 v60, v44, v19
    v_fmac_f32 v61, v44, v20
    v_lshlrev_b32 v19, 16, v67
    v_and_b32 v20, 0xffff0000, v67
    v_fmac_f32 v62, v44, v19
    v_fmac_f32 v63, v44, v20
    v_add_u32 v2, 122880, v21
    buffer_load_dwordx4 v[64:67], v2, s[52:55], 0 offen
    s_waitcnt vmcnt(19)
    v_lshlrev_b32 v19, 16, v68
    v_and_b32 v20, 0xffff0000, v68
    v_fmac_f32 v56, v45, v19
    v_fmac_f32 v57, v45, v20
    v_lshlrev_b32 v19, 16, v69
    v_and_b32 v20, 0xffff0000, v69
    v_fmac_f32 v58, v45, v19
    v_fmac_f32 v59, v45, v20
    v_lshlrev_b32 v19, 16, v70
    v_and_b32 v20, 0xffff0000, v70
    v_fmac_f32 v60, v45, v19
    v_fmac_f32 v61, v45, v20
    v_lshlrev_b32 v19, 16, v71
    v_and_b32 v20, 0xffff0000, v71
    v_fmac_f32 v62, v45, v19
    v_fmac_f32 v63, v45, v20
    v_add_u32 v2, 138240, v21
    buffer_load_dwordx4 v[68:71], v2, s[52:55], 0 offen
    s_waitcnt vmcnt(19)
    v_lshlrev_b32 v19, 16, v72
    v_and_b32 v20, 0xffff0000, v72
    v_fmac_f32 v56, v46, v19
    v_fmac_f32 v57, v46, v20
    v_lshlrev_b32 v19, 16, v73
    v_and_b32 v20, 0xffff0000, v73
    v_fmac_f32 v58, v46, v19
    v_fmac_f32 v59, v46, v20
    v_lshlrev_b32 v19, 16, v74
    v_and_b32 v20, 0xffff0000, v74
    v_fmac_f32 v60, v46, v19
    v_fmac_f32 v61, v46, v20
    v_lshlrev_b32 v19, 16, v75
    v_and_b32 v20, 0xffff0000, v75
    v_fmac_f32 v62, v46, v19
    v_fmac_f32 v63, v46, v20
    v_add_u32 v2, 153600, v21
    buffer_load_dwordx4 v[72:75], v2, s[52:55], 0 offen
    s_waitcnt vmcnt(19)
    v_lshlrev_b32 v19, 16, v76
    v_and_b32 v20, 0xffff0000, v76
    v_fmac_f32 v56, v47, v19
    v_fmac_f32 v57, v47, v20
    v_lshlrev_b32 v19, 16, v77
    v_and_b32 v20, 0xffff0000, v77
    v_fmac_f32 v58, v47, v19
    v_fmac_f32 v59, v47, v20
    v_lshlrev_b32 v19, 16, v78
    v_and_b32 v20, 0xffff0000, v78
    v_fmac_f32 v60, v47, v19
    v_fmac_f32 v61, v47, v20
    v_lshlrev_b32 v19, 16, v79
    v_and_b32 v20, 0xffff0000, v79
    v_fmac_f32 v62, v47, v19
    v_fmac_f32 v63, v47, v20
    s_waitcnt vmcnt(18)
    v_lshlrev_b32 v19, 16, v80
    v_and_b32 v20, 0xffff0000, v80
    v_fmac_f32 v56, v48, v19
    v_fmac_f32 v57, v48, v20
    v_lshlrev_b32 v19, 16, v81
    v_and_b32 v20, 0xffff0000, v81
    v_fmac_f32 v58, v48, v19
    v_fmac_f32 v59, v48, v20
    v_lshlrev_b32 v19, 16, v82
    v_and_b32 v20, 0xffff0000, v82
    v_fmac_f32 v60, v48, v19
    v_fmac_f32 v61, v48, v20
    v_lshlrev_b32 v19, 16, v83
    v_and_b32 v20, 0xffff0000, v83
    v_fmac_f32 v62, v48, v19
    v_fmac_f32 v63, v48, v20
    s_waitcnt vmcnt(17)
    v_lshlrev_b32 v19, 16, v84
    v_and_b32 v20, 0xffff0000, v84
    v_fmac_f32 v56, v49, v19
    v_fmac_f32 v57, v49, v20
    v_lshlrev_b32 v19, 16, v85
    v_and_b32 v20, 0xffff0000, v85
    v_fmac_f32 v58, v49, v19
    v_fmac_f32 v59, v49, v20
    v_lshlrev_b32 v19, 16, v86
    v_and_b32 v20, 0xffff0000, v86
    v_fmac_f32 v60, v49, v19
    v_fmac_f32 v61, v49, v20
    v_lshlrev_b32 v19, 16, v87
    v_and_b32 v20, 0xffff0000, v87
    v_fmac_f32 v62, v49, v19
    v_fmac_f32 v63, v49, v20
    s_waitcnt vmcnt(16)
    v_lshlrev_b32 v19, 16, v88
    v_and_b32 v20, 0xffff0000, v88
    v_fmac_f32 v56, v50, v19
    v_fmac_f32 v57, v50, v20
    v_lshlrev_b32 v19, 16, v89
    v_and_b32 v20, 0xffff0000, v89
    v_fmac_f32 v58, v50, v19
    v_fmac_f32 v59, v50, v20
    v_lshlrev_b32 v19, 16, v90
    v_and_b32 v20, 0xffff0000, v90
    v_fmac_f32 v60, v50, v19
    v_fmac_f32 v61, v50, v20
    v_lshlrev_b32 v19, 16, v91
    v_and_b32 v20, 0xffff0000, v91
    v_fmac_f32 v62, v50, v19
    v_fmac_f32 v63, v50, v20
    s_waitcnt vmcnt(15)
    v_lshlrev_b32 v19, 16, v92
    v_and_b32 v20, 0xffff0000, v92
    v_fmac_f32 v56, v51, v19
    v_fmac_f32 v57, v51, v20
    v_lshlrev_b32 v19, 16, v93
    v_and_b32 v20, 0xffff0000, v93
    v_fmac_f32 v58, v51, v19
    v_fmac_f32 v59, v51, v20
    v_lshlrev_b32 v19, 16, v94
    v_and_b32 v20, 0xffff0000, v94
    v_fmac_f32 v60, v51, v19
    v_fmac_f32 v61, v51, v20
    v_lshlrev_b32 v19, 16, v95
    v_and_b32 v20, 0xffff0000, v95
    v_fmac_f32 v62, v51, v19
    v_fmac_f32 v63, v51, v20
    s_waitcnt vmcnt(14)
    v_lshlrev_b32 v19, 16, v96
    v_and_b32 v20, 0xffff0000, v96
    v_fmac_f32 v56, v52, v19
    v_fmac_f32 v57, v52, v20
    v_lshlrev_b32 v19, 16, v97
    v_and_b32 v20, 0xffff0000, v97
    v_fmac_f32 v58, v52, v19
    v_fmac_f32 v59, v52, v20
    v_lshlrev_b32 v19, 16, v98
    v_and_b32 v20, 0xffff0000, v98
    v_fmac_f32 v60, v52, v19
    v_fmac_f32 v61, v52, v20
    v_lshlrev_b32 v19, 16, v99
    v_and_b32 v20, 0xffff0000, v99
    v_fmac_f32 v62, v52, v19
    v_fmac_f32 v63, v52, v20
    s_waitcnt vmcnt(13)
    v_lshlrev_b32 v19, 16, v100
    v_and_b32 v20, 0xffff0000, v100
    v_fmac_f32 v56, v53, v19
    v_fmac_f32 v57, v53, v20
    v_lshlrev_b32 v19, 16, v101
    v_and_b32 v20, 0xffff0000, v101
    v_fmac_f32 v58, v53, v19
    v_fmac_f32 v59, v53, v20
    v_lshlrev_b32 v19, 16, v102
    v_and_b32 v20, 0xffff0000, v102
    v_fmac_f32 v60, v53, v19
    v_fmac_f32 v61, v53, v20
    v_lshlrev_b32 v19, 16, v103
    v_and_b32 v20, 0xffff0000, v103
    v_fmac_f32 v62, v53, v19
    v_fmac_f32 v63, v53, v20
    s_waitcnt vmcnt(12)
    v_lshlrev_b32 v19, 16, v104
    v_and_b32 v20, 0xffff0000, v104
    v_fmac_f32 v56, v54, v19
    v_fmac_f32 v57, v54, v20
    v_lshlrev_b32 v19, 16, v105
    v_and_b32 v20, 0xffff0000, v105
    v_fmac_f32 v58, v54, v19
    v_fmac_f32 v59, v54, v20
    v_lshlrev_b32 v19, 16, v106
    v_and_b32 v20, 0xffff0000, v106
    v_fmac_f32 v60, v54, v19
    v_fmac_f32 v61, v54, v20
    v_lshlrev_b32 v19, 16, v107
    v_and_b32 v20, 0xffff0000, v107
    v_fmac_f32 v62, v54, v19
    v_fmac_f32 v63, v54, v20
    s_waitcnt vmcnt(11)
    v_lshlrev_b32 v19, 16, v108
    v_and_b32 v20, 0xffff0000, v108
    v_fmac_f32 v56, v55, v19
    v_fmac_f32 v57, v55, v20
    v_lshlrev_b32 v19, 16, v109
    v_and_b32 v20, 0xffff0000, v109
    v_fmac_f32 v58, v55, v19
    v_fmac_f32 v59, v55, v20
    v_lshlrev_b32 v19, 16, v110
    v_and_b32 v20, 0xffff0000, v110
    v_fmac_f32 v60, v55, v19
    v_fmac_f32 v61, v55, v20
    v_lshlrev_b32 v19, 16, v111
    v_and_b32 v20, 0xffff0000, v111
    v_fmac_f32 v62, v55, v19
    v_fmac_f32 v63, v55, v20
    v_bfe_u32 v2, v0, 4, 6
    v_lshlrev_b32 v2, 2, v2
    ds_write_b32 v2, v16 offset:18816
    s_waitcnt lgkmcnt(0)
    s_barrier
    v_and_b32 v2, 63, v0
    v_lshlrev_b32 v2, 2, v2
    ds_read_b32 v17, v2 offset:18816
    s_waitcnt lgkmcnt(0)
    s_nop 0
    v_max_f32_dpp v17, v17, v17 row_ror:8 row_mask:0xf bank_mask:0xf
    s_nop 1
    v_max_f32_dpp v17, v17, v17 row_ror:4 row_mask:0xf bank_mask:0xf
    s_nop 1
    v_max_f32_dpp v17, v17, v17 row_ror:2 row_mask:0xf bank_mask:0xf
    s_nop 1
    v_max_f32_dpp v17, v17, v17 row_ror:1 row_mask:0xf bank_mask:0xf
    s_nop 1
    v_mov_b32 v19, v17
    s_nop 1
    v_permlane16_swap_b32 v17, v19
    v_max_f32 v17, v17, v19
    v_mov_b32 v19, v17
    s_nop 1
    v_permlane32_swap_b32 v17, v19
    v_max_f32 v17, v17, v19
    v_sub_f32 v19, v16, v17
    v_mul_f32 v19, 0x3fb8aa3b, v19
    v_exp_f32 v19, v19
    s_nop 0
    v_mul_f32 v56, v56, v19
    v_mul_f32 v57, v57, v19
    v_mul_f32 v58, v58, v19
    v_mul_f32 v59, v59, v19
    v_mul_f32 v60, v60, v19
    v_mul_f32 v61, v61, v19
    v_mul_f32 v62, v62, v19
    v_mul_f32 v63, v63, v19
    v_mul_f32 v18, v18, v19
    v_mov_b32 v40, v56
    v_mov_b32 v41, v57
    v_mov_b32 v42, v58
    v_mov_b32 v43, v59
    v_mov_b32 v44, v60
    v_mov_b32 v45, v61
    v_mov_b32 v46, v62
    v_mov_b32 v47, v63
    v_mov_b32 v48, v18
    s_nop 1
    v_permlane16_swap_b32 v56, v40
    v_permlane16_swap_b32 v57, v41
    v_permlane16_swap_b32 v58, v42
    v_permlane16_swap_b32 v59, v43
    v_permlane16_swap_b32 v60, v44
    v_permlane16_swap_b32 v61, v45
    v_permlane16_swap_b32 v62, v46
    v_permlane16_swap_b32 v63, v47
    v_permlane16_swap_b32 v18, v48
    v_add_f32 v56, v56, v40
    v_add_f32 v57, v57, v41
    v_add_f32 v58, v58, v42
    v_add_f32 v59, v59, v43
    v_add_f32 v60, v60, v44
    v_add_f32 v61, v61, v45
    v_add_f32 v62, v62, v46
    v_add_f32 v63, v63, v47
    v_add_f32 v18, v18, v48
    v_mov_b32 v40, v56
    v_mov_b32 v41, v57
    v_mov_b32 v42, v58
    v_mov_b32 v43, v59
    v_mov_b32 v44, v60
    v_mov_b32 v45, v61
    v_mov_b32 v46, v62
    v_mov_b32 v47, v63
    v_mov_b32 v48, v18
    s_nop 1
    v_permlane32_swap_b32 v56, v40
    v_permlane32_swap_b32 v57, v41
    v_permlane32_swap_b32 v58, v42
    v_permlane32_swap_b32 v59, v43
    v_permlane32_swap_b32 v60, v44
    v_permlane32_swap_b32 v61, v45
    v_permlane32_swap_b32 v62, v46
    v_permlane32_swap_b32 v63, v47
    v_permlane32_swap_b32 v18, v48
    v_add_f32 v56, v56, v40
    v_add_f32 v57, v57, v41
    v_add_f32 v58, v58, v42
    v_add_f32 v59, v59, v43
    v_add_f32 v60, v60, v44
    v_add_f32 v61, v61, v45
    v_add_f32 v62, v62, v46
    v_add_f32 v63, v63, v47
    v_add_f32 v18, v18, v48
    v_and_b32 v2, 15, v0
    v_lshlrev_b32 v2, 5, v2
    v_add_u32 v2, s78, v2
    ds_write_b128 v2, v[56:59] offset:20480
    ds_write_b128 v2, v[60:63] offset:20496
    v_mov_b32 v2, s69
    v_lshlrev_b32 v2, 2, v2
    ds_write_b32 v2, v18 offset:19072
    s_waitcnt lgkmcnt(0)
    s_barrier
    s_cmp_ge_u32 s69, 2
    s_cbranch_scc1 Lo0_a
    v_lshlrev_b32 v2, 2, v0
    ds_read_b32 v40, v2 offset:20480
    ds_read_b32 v41, v2 offset:20992
    ds_read_b32 v42, v2 offset:21504
    ds_read_b32 v43, v2 offset:22016
    ds_read_b32 v44, v2 offset:22528
    ds_read_b32 v45, v2 offset:23040
    ds_read_b32 v46, v2 offset:23552
    ds_read_b32 v47, v2 offset:24064
    ds_read_b32 v48, v2 offset:24576
    ds_read_b32 v49, v2 offset:25088
    ds_read_b32 v50, v2 offset:25600
    ds_read_b32 v51, v2 offset:26112
    ds_read_b32 v52, v2 offset:26624
    ds_read_b32 v53, v2 offset:27136
    ds_read_b32 v54, v2 offset:27648
    ds_read_b32 v55, v2 offset:28160
    s_waitcnt lgkmcnt(0)
    v_add_f32 v40, v40, v41
    v_add_f32 v40, v40, v42
    v_add_f32 v40, v40, v43
    v_add_f32 v40, v40, v44
    v_add_f32 v40, v40, v45
    v_add_f32 v40, v40, v46
    v_add_f32 v40, v40, v47
    v_add_f32 v40, v40, v48
    v_add_f32 v40, v40, v49
    v_add_f32 v40, v40, v50
    v_add_f32 v40, v40, v51
    v_add_f32 v40, v40, v52
    v_add_f32 v40, v40, v53
    v_add_f32 v40, v40, v54
    v_add_f32 v40, v40, v55
    ds_write_b32 v2, v40 offset:19200
    s_branch Lo0_b
Lo0_a:
    s_cmp_lg_u32 s69, 2
    s_cbranch_scc1 Lo0_c
    v_lshlrev_b32 v2, 2, v0
    v_mov_b32 v3, 0
    ds_write_b32 v2, v3 offset:19200
    s_branch Lo0_b
Lo0_c:
    s_cmp_lg_u32 s69, 3
    s_cbranch_scc1 Lo0_b
    v_mov_b32 v2, 0
    ds_read_b128 v[40:43], v2 offset:19072
    ds_read_b128 v[44:47], v2 offset:19088
    ds_read_b128 v[48:51], v2 offset:19104
    ds_read_b128 v[52:55], v2 offset:19120
    s_waitcnt lgkmcnt(0)
    v_add_f32 v40, v40, v41
    v_add_f32 v40, v40, v42
    v_add_f32 v40, v40, v43
    v_add_f32 v40, v40, v44
    v_add_f32 v40, v40, v45
    v_add_f32 v40, v40, v46
    v_add_f32 v40, v40, v47
    v_add_f32 v40, v40, v48
    v_add_f32 v40, v40, v49
    v_add_f32 v40, v40, v50
    v_add_f32 v40, v40, v51
    v_add_f32 v40, v40, v52
    v_add_f32 v40, v40, v53
    v_add_f32 v40, v40, v54
    v_add_f32 v40, v40, v55
    v_mov_b32 v41, v40
    v_mov_b32 v40, v17
    v_mov_b32 v2, s92
    buffer_store_dwordx2 v[40:41], v2, s[64:67], 0 offen
Lo0_b:
    s_waitcnt lgkmcnt(0)
    s_barrier
    v_lshlrev_b32 v2, 2, v22
    ds_read_b32 v40, v2 offset:19200
    ds_read_b32 v41, v2 offset:19248
    ds_read_b32 v42, v2 offset:19296
    ds_read_b32 v43, v2 offset:19344
    ds_read_b32 v44, v2 offset:19392
    ds_read_b32 v45, v2 offset:19440
    ds_read_b32 v46, v2 offset:19488
    ds_read_b32 v47, v2 offset:19536
    ds_read_b32 v48, v2 offset:19584
    ds_read_b32 v49, v2 offset:19632
    ds_read_b32 v50, v2 offset:19680
    v_mov_b32 v56, 0
    v_mov_b32 v57, 0
    v_mov_b32 v58, 0
    v_mov_b32 v59, 0
    v_mov_b32 v60, 0
    v_mov_b32 v61, 0
    v_mov_b32 v62, 0
    v_mov_b32 v63, 0
    s_waitcnt lgkmcnt(0)
    s_waitcnt vmcnt(10)
    v_lshlrev_b32 v19, 16, v112
    v_and_b32 v20, 0xffff0000, v112
    v_fmac_f32 v56, v40, v19
    v_fmac_f32 v57, v40, v20
    v_lshlrev_b32 v19, 16, v113
    v_and_b32 v20, 0xffff0000, v113
    v_fmac_f32 v58, v40, v19
    v_fmac_f32 v59, v40, v20
    v_lshlrev_b32 v19, 16, v114
    v_and_b32 v20, 0xffff0000, v114
    v_fmac_f32 v60, v40, v19
    v_fmac_f32 v61, v40, v20
    v_lshlrev_b32 v19, 16, v115
    v_and_b32 v20, 0xffff0000, v115
    v_fmac_f32 v62, v40, v19
    v_fmac_f32 v63, v40, v20
    s_waitcnt vmcnt(9)
    v_lshlrev_b32 v19, 16, v116
    v_and_b32 v20, 0xffff0000, v116
    v_fmac_f32 v56, v41, v19
    v_fmac_f32 v57, v41, v20
    v_lshlrev_b32 v19, 16, v117
    v_and_b32 v20, 0xffff0000, v117
    v_fmac_f32 v58, v41, v19
    v_fmac_f32 v59, v41, v20
    v_lshlrev_b32 v19, 16, v118
    v_and_b32 v20, 0xffff0000, v118
    v_fmac_f32 v60, v41, v19
    v_fmac_f32 v61, v41, v20
    v_lshlrev_b32 v19, 16, v119
    v_and_b32 v20, 0xffff0000, v119
    v_fmac_f32 v62, v41, v19
    v_fmac_f32 v63, v41, v20
    s_waitcnt vmcnt(8)
    v_lshlrev_b32 v19, 16, v120
    v_and_b32 v20, 0xffff0000, v120
    v_fmac_f32 v56, v42, v19
    v_fmac_f32 v57, v42, v20
    v_lshlrev_b32 v19, 16, v121
    v_and_b32 v20, 0xffff0000, v121
    v_fmac_f32 v58, v42, v19
    v_fmac_f32 v59, v42, v20
    v_lshlrev_b32 v19, 16, v122
    v_and_b32 v20, 0xffff0000, v122
    v_fmac_f32 v60, v42, v19
    v_fmac_f32 v61, v42, v20
    v_lshlrev_b32 v19, 16, v123
    v_and_b32 v20, 0xffff0000, v123
    v_fmac_f32 v62, v42, v19
    v_fmac_f32 v63, v42, v20
    s_waitcnt vmcnt(7)
    v_lshlrev_b32 v19, 16, v124
    v_and_b32 v20, 0xffff0000, v124
    v_fmac_f32 v56, v43, v19
    v_fmac_f32 v57, v43, v20
    v_lshlrev_b32 v19, 16, v125
    v_and_b32 v20, 0xffff0000, v125
    v_fmac_f32 v58, v43, v19
    v_fmac_f32 v59, v43, v20
    v_lshlrev_b32 v19, 16, v126
    v_and_b32 v20, 0xffff0000, v126
    v_fmac_f32 v60, v43, v19
    v_fmac_f32 v61, v43, v20
    v_lshlrev_b32 v19, 16, v127
    v_and_b32 v20, 0xffff0000, v127
    v_fmac_f32 v62, v43, v19
    v_fmac_f32 v63, v43, v20
    s_waitcnt vmcnt(6)
    v_lshlrev_b32 v19, 16, v24
    v_and_b32 v20, 0xffff0000, v24
    v_fmac_f32 v56, v44, v19
    v_fmac_f32 v57, v44, v20
    v_lshlrev_b32 v19, 16, v25
    v_and_b32 v20, 0xffff0000, v25
    v_fmac_f32 v58, v44, v19
    v_fmac_f32 v59, v44, v20
    v_lshlrev_b32 v19, 16, v26
    v_and_b32 v20, 0xffff0000, v26
    v_fmac_f32 v60, v44, v19
    v_fmac_f32 v61, v44, v20
    v_lshlrev_b32 v19, 16, v27
    v_and_b32 v20, 0xffff0000, v27
    v_fmac_f32 v62, v44, v19
    v_fmac_f32 v63, v44, v20
    s_waitcnt vmcnt(5)
    v_lshlrev_b32 v19, 16, v28
    v_and_b32 v20, 0xffff0000, v28
    v_fmac_f32 v56, v45, v19
    v_fmac_f32 v57, v45, v20
    v_lshlrev_b32 v19, 16, v29
    v_and_b32 v20, 0xffff0000, v29
    v_fmac_f32 v58, v45, v19
    v_fmac_f32 v59, v45, v20
    v_lshlrev_b32 v19, 16, v30
    v_and_b32 v20, 0xffff0000, v30
    v_fmac_f32 v60, v45, v19
    v_fmac_f32 v61, v45, v20
    v_lshlrev_b32 v19, 16, v31
    v_and_b32 v20, 0xffff0000, v31
    v_fmac_f32 v62, v45, v19
    v_fmac_f32 v63, v45, v20
    s_waitcnt vmcnt(4)
    v_lshlrev_b32 v19, 16, v32
    v_and_b32 v20, 0xffff0000, v32
    v_fmac_f32 v56, v46, v19
    v_fmac_f32 v57, v46, v20
    v_lshlrev_b32 v19, 16, v33
    v_and_b32 v20, 0xffff0000, v33
    v_fmac_f32 v58, v46, v19
    v_fmac_f32 v59, v46, v20
    v_lshlrev_b32 v19, 16, v34
    v_and_b32 v20, 0xffff0000, v34
    v_fmac_f32 v60, v46, v19
    v_fmac_f32 v61, v46, v20
    v_lshlrev_b32 v19, 16, v35
    v_and_b32 v20, 0xffff0000, v35
    v_fmac_f32 v62, v46, v19
    v_fmac_f32 v63, v46, v20
    s_waitcnt vmcnt(3)
    v_lshlrev_b32 v19, 16, v36
    v_and_b32 v20, 0xffff0000, v36
    v_fmac_f32 v56, v47, v19
    v_fmac_f32 v57, v47, v20
    v_lshlrev_b32 v19, 16, v37
    v_and_b32 v20, 0xffff0000, v37
    v_fmac_f32 v58, v47, v19
    v_fmac_f32 v59, v47, v20
    v_lshlrev_b32 v19, 16, v38
    v_and_b32 v20, 0xffff0000, v38
    v_fmac_f32 v60, v47, v19
    v_fmac_f32 v61, v47, v20
    v_lshlrev_b32 v19, 16, v39
    v_and_b32 v20, 0xffff0000, v39
    v_fmac_f32 v62, v47, v19
    v_fmac_f32 v63, v47, v20
    s_waitcnt vmcnt(2)
    v_lshlrev_b32 v19, 16, v64
    v_and_b32 v20, 0xffff0000, v64
    v_fmac_f32 v56, v48, v19
    v_fmac_f32 v57, v48, v20
    v_lshlrev_b32 v19, 16, v65
    v_and_b32 v20, 0xffff0000, v65
    v_fmac_f32 v58, v48, v19
    v_fmac_f32 v59, v48, v20
    v_lshlrev_b32 v19, 16, v66
    v_and_b32 v20, 0xffff0000, v66
    v_fmac_f32 v60, v48, v19
    v_fmac_f32 v61, v48, v20
    v_lshlrev_b32 v19, 16, v67
    v_and_b32 v20, 0xffff0000, v67
    v_fmac_f32 v62, v48, v19
    v_fmac_f32 v63, v48, v20
    s_waitcnt vmcnt(1)
    v_lshlrev_b32 v19, 16, v68
    v_and_b32 v20, 0xffff0000, v68
    v_fmac_f32 v56, v49, v19
    v_fmac_f32 v57, v49, v20
    v_lshlrev_b32 v19, 16, v69
    v_and_b32 v20, 0xffff0000, v69
    v_fmac_f32 v58, v49, v19
    v_fmac_f32 v59, v49, v20
    v_lshlrev_b32 v19, 16, v70
    v_and_b32 v20, 0xffff0000, v70
    v_fmac_f32 v60, v49, v19
    v_fmac_f32 v61, v49, v20
    v_lshlrev_b32 v19, 16, v71
    v_and_b32 v20, 0xffff0000, v71
    v_fmac_f32 v62, v49, v19
    v_fmac_f32 v63, v49, v20
    s_waitcnt vmcnt(0)
    v_lshlrev_b32 v19, 16, v72
    v_and_b32 v20, 0xffff0000, v72
    v_fmac_f32 v56, v50, v19
    v_fmac_f32 v57, v50, v20
    v_lshlrev_b32 v19, 16, v73
    v_and_b32 v20, 0xffff0000, v73
    v_fmac_f32 v58, v50, v19
    v_fmac_f32 v59, v50, v20
    v_lshlrev_b32 v19, 16, v74
    v_and_b32 v20, 0xffff0000, v74
    v_fmac_f32 v60, v50, v19
    v_fmac_f32 v61, v50, v20
    v_lshlrev_b32 v19, 16, v75
    v_and_b32 v20, 0xffff0000, v75
    v_fmac_f32 v62, v50, v19
    v_fmac_f32 v63, v50, v20
    v_mov_b32 v3, 2560
    v_mul_u32_u24 v2, v22, v3
    v_lshl_add_u32 v2, v23, 5, v2
    ds_write_b128 v2, v[56:59] offset:28672
    ds_write_b128 v2, v[60:63] offset:28688
    s_waitcnt lgkmcnt(0)
    s_barrier
    s_cmp_ge_u32 s69, 10
    s_cbranch_scc1 Lk1_end
    v_lshlrev_b32 v2, 2, v0
    ds_read_b32 v40, v2 offset:28672
    ds_read_b32 v41, v2 offset:31232
    ds_read_b32 v42, v2 offset:33792
    ds_read_b32 v43, v2 offset:36352
    ds_read_b32 v44, v2 offset:38912
    ds_read_b32 v45, v2 offset:41472
    ds_read_b32 v46, v2 offset:44032
    ds_read_b32 v47, v2 offset:46592
    ds_read_b32 v48, v2 offset:49152
    ds_read_b32 v49, v2 offset:51712
    ds_read_b32 v50, v2 offset:54272
    ds_read_b32 v51, v2 offset:56832
    s_waitcnt lgkmcnt(0)
    v_add_f32 v40, v40, v41
    v_add_f32 v40, v40, v42
    v_add_f32 v40, v40, v43
    v_add_f32 v40, v40, v44
    v_add_f32 v40, v40, v45
    v_add_f32 v40, v40, v46
    v_add_f32 v40, v40, v47
    v_add_f32 v40, v40, v48
    v_add_f32 v40, v40, v49
    v_add_f32 v40, v40, v50
    v_add_f32 v40, v40, v51
    v_add_u32 v2, s93, v2
    buffer_store_dword v40, v2, s[64:67], 0 offen
    s_branch Lk1_end
Lk1_ffn:
    v_lshlrev_b32 v2, 1, v0
    buffer_load_ushort v16, v2, s[36:39], 0 offen
    buffer_load_ushort v17, v2, s[36:39], 0 offen offset:1280
    v_bfe_u32 v8, v0, 4, 2
    v_and_b32 v9, 15, v0
    v_mul_u32_u24 v3, 10, v8
    v_add_u32 v3, s70, v3
    v_lshlrev_b32 v3, 13, v3
    v_lshl_add_u32 v3, v9, 4, v3
    buffer_load_dwordx4 v[24:27], v3, s[48:51], s80 offen
    buffer_load_dwordx4 v[28:31], v3, s[48:51], s81 offen
    buffer_load_dwordx4 v[32:35], v3, s[48:51], s82 offen
    buffer_load_dwordx4 v[36:39], v3, s[48:51], s83 offen
    buffer_load_dwordx4 v[40:43], v3, s[48:51], s84 offen
    buffer_load_dwordx4 v[44:47], v3, s[48:51], s85 offen
    buffer_load_dwordx4 v[48:51], v3, s[48:51], s86 offen
    buffer_load_dwordx4 v[52:55], v3, s[48:51], s87 offen
    buffer_load_dwordx4 v[56:59], v3, s[48:51], s88 offen
    buffer_load_dwordx4 v[60:63], v3, s[48:51], s89 offen
    v_lshrrev_b32 v10, 3, v0
    v_mul_u32_u24 v10, 5, v10
    v_mov_b32 v11, 3456
    v_mul_u32_u24 v10, v10, v11
    v_and_b32 v11, 7, v0
    v_lshl_add_u32 v10, v11, 2, v10
    v_add_u32 v10, s71, v10
    buffer_load_dword v104, v10, s[56:59], 0 offen
    v_add_u32 v10, 3456, v10
    buffer_load_dword v105, v10, s[56:59], 0 offen
    v_add_u32 v10, 3456, v10
    buffer_load_dword v106, v10, s[56:59], 0 offen
    v_add_u32 v10, 3456, v10
    buffer_load_dword v107, v10, s[56:59], 0 offen
    v_add_u32 v10, 3456, v10
    buffer_load_dword v108, v10, s[56:59], 0 offen
    v_lshlrev_b32 v10, 2, v0
    v_add_u32 v10, s72, v10
    buffer_load_dword v112, v10, s[60:63], 0 offen
    v_add_u32 v10, 1280, v10
    buffer_load_dword v113, v10, s[60:63], 0 offen
    v_add_u32 v10, 1280, v10
    buffer_load_dword v114, v10, s[60:63], 0 offen
    v_add_u32 v10, 1280, v10
    buffer_load_dword v115, v10, s[60:63], 0 offen
    v_add_u32 v10, 1280, v10
    buffer_load_dword v116, v10, s[60:63], 0 offen
    v_add_u32 v10, 1280, v10
    buffer_load_dword v117, v10, s[60:63], 0 offen
    v_add_u32 v10, 1280, v10
    buffer_load_dword v118, v10, s[60:63], 0 offen
    v_add_u32 v10, 1280, v10
    buffer_load_dword v119, v10, s[60:63], 0 offen
    v_add_u32 v10, 1280, v10
    buffer_load_dword v120, v10, s[60:63], 0 offen
    v_add_u32 v10, 1280, v10
    buffer_load_dword v121, v10, s[60:63], 0 offen
    v_add_u32 v10, 1280, v10
    buffer_load_dword v122, v10, s[60:63], 0 offen
    v_add_u32 v10, 1280, v10
    buffer_load_dword v123, v10, s[60:63], 0 offen
    v_add_u32 v10, 1280, v10
    buffer_load_dword v124, v10, s[60:63], 0 offen
    v_add_u32 v10, 1280, v10
    buffer_load_dword v125, v10, s[60:63], 0 offen
    v_add_u32 v10, 1280, v10
    buffer_load_dword v126, v10, s[60:63], 0 offen
    v_add_u32 v10, 1280, v10
    buffer_load_dword v127, v10, s[60:63], 0 offen
    s_barrier
    v_lshlrev_b32 v1, 8, v8
    v_add_u32 v1, s73, v1
    v_lshl_add_u32 v1, v9, 4, v1
    buffer_load_dwordx4 v[64:67], v1, s[40:43], 0 offen offset:0 nt
    buffer_load_dwordx4 v[68:71], v1, s[40:43], 0 offen offset:1024 nt
    buffer_load_dwordx4 v[72:75], v1, s[40:43], 0 offen offset:2048 nt
    buffer_load_dwordx4 v[76:79], v1, s[40:43], 0 offen offset:3072 nt
    buffer_load_dwordx4 v[80:83], v1, s[40:43], s74 offen offset:0 nt
    buffer_load_dwordx4 v[84:87], v1, s[40:43], s74 offen offset:1024 nt
    buffer_load_dwordx4 v[88:91], v1, s[40:43], s74 offen offset:2048 nt
    buffer_load_dwordx4 v[92:95], v1, s[40:43], s74 offen offset:3072 nt
    buffer_load_dwordx4 v[96:99], v1, s[40:43], s75 offen offset:0 nt
    buffer_load_dwordx4 v[100:103], v1, s[40:43], s75 offen offset:1024 nt
    s_waitcnt vmcnt(41)
    v_lshlrev_b32 v16, 16, v16
    v_lshlrev_b32 v17, 16, v17
    v_lshlrev_b32 v2, 2, v0
    ds_write_b32 v2, v16 offset:0
    ds_write_b32 v2, v17 offset:4096
    s_waitcnt lgkmcnt(0)
    s_barrier
    v_mul_u32_u24 v2, 10, v8
    v_add_u32 v2, s70, v2
    v_lshlrev_b32 v2, 2, v2
    v_add_u32 v2, s77, v2
    v_mov_b32 v22, v8
    v_mov_b32 v23, v9
    v_mov_b32 v8, 0
    v_mov_b32 v9, 0
    v_mov_b32 v10, 0
    v_mov_b32 v11, 0
    v_mov_b32 v12, 0
    v_mov_b32 v13, 0
    v_mov_b32 v14, 0
    v_mov_b32 v15, 0
    ds_read_b64 v[16:17], v2 offset:0
    ds_read_b64 v[18:19], v2 offset:8
    ds_read_b32 v20, v2 offset:16
    s_waitcnt lgkmcnt(0)
    s_waitcnt vmcnt(40)
    v_lshlrev_b32 v21, 16, v24
    v_and_b32 v3, 0xffff0000, v24
    v_fmac_f32 v8, v16, v21
    v_fmac_f32 v9, v16, v3
    v_lshlrev_b32 v21, 16, v25
    v_and_b32 v3, 0xffff0000, v25
    v_fmac_f32 v10, v16, v21
    v_fmac_f32 v11, v16, v3
    v_lshlrev_b32 v21, 16, v26
    v_and_b32 v3, 0xffff0000, v26
    v_fmac_f32 v12, v16, v21
    v_fmac_f32 v13, v16, v3
    v_lshlrev_b32 v21, 16, v27
    v_and_b32 v3, 0xffff0000, v27
    v_fmac_f32 v14, v16, v21
    v_fmac_f32 v15, v16, v3
    s_waitcnt vmcnt(39)
    v_lshlrev_b32 v21, 16, v28
    v_and_b32 v3, 0xffff0000, v28
    v_fmac_f32 v8, v17, v21
    v_fmac_f32 v9, v17, v3
    v_lshlrev_b32 v21, 16, v29
    v_and_b32 v3, 0xffff0000, v29
    v_fmac_f32 v10, v17, v21
    v_fmac_f32 v11, v17, v3
    v_lshlrev_b32 v21, 16, v30
    v_and_b32 v3, 0xffff0000, v30
    v_fmac_f32 v12, v17, v21
    v_fmac_f32 v13, v17, v3
    v_lshlrev_b32 v21, 16, v31
    v_and_b32 v3, 0xffff0000, v31
    v_fmac_f32 v14, v17, v21
    v_fmac_f32 v15, v17, v3
    s_waitcnt vmcnt(38)
    v_lshlrev_b32 v21, 16, v32
    v_and_b32 v3, 0xffff0000, v32
    v_fmac_f32 v8, v18, v21
    v_fmac_f32 v9, v18, v3
    v_lshlrev_b32 v21, 16, v33
    v_and_b32 v3, 0xffff0000, v33
    v_fmac_f32 v10, v18, v21
    v_fmac_f32 v11, v18, v3
    v_lshlrev_b32 v21, 16, v34
    v_and_b32 v3, 0xffff0000, v34
    v_fmac_f32 v12, v18, v21
    v_fmac_f32 v13, v18, v3
    v_lshlrev_b32 v21, 16, v35
    v_and_b32 v3, 0xffff0000, v35
    v_fmac_f32 v14, v18, v21
    v_fmac_f32 v15, v18, v3
    s_waitcnt vmcnt(37)
    v_lshlrev_b32 v21, 16, v36
    v_and_b32 v3, 0xffff0000, v36
    v_fmac_f32 v8, v19, v21
    v_fmac_f32 v9, v19, v3
    v_lshlrev_b32 v21, 16, v37
    v_and_b32 v3, 0xffff0000, v37
    v_fmac_f32 v10, v19, v21
    v_fmac_f32 v11, v19, v3
    v_lshlrev_b32 v21, 16, v38
    v_and_b32 v3, 0xffff0000, v38
    v_fmac_f32 v12, v19, v21
    v_fmac_f32 v13, v19, v3
    v_lshlrev_b32 v21, 16, v39
    v_and_b32 v3, 0xffff0000, v39
    v_fmac_f32 v14, v19, v21
    v_fmac_f32 v15, v19, v3
    s_waitcnt vmcnt(36)
    v_lshlrev_b32 v21, 16, v40
    v_and_b32 v3, 0xffff0000, v40
    v_fmac_f32 v8, v20, v21
    v_fmac_f32 v9, v20, v3
    v_lshlrev_b32 v21, 16, v41
    v_and_b32 v3, 0xffff0000, v41
    v_fmac_f32 v10, v20, v21
    v_fmac_f32 v11, v20, v3
    v_lshlrev_b32 v21, 16, v42
    v_and_b32 v3, 0xffff0000, v42
    v_fmac_f32 v12, v20, v21
    v_fmac_f32 v13, v20, v3
    v_lshlrev_b32 v21, 16, v43
    v_and_b32 v3, 0xffff0000, v43
    v_fmac_f32 v14, v20, v21
    v_fmac_f32 v15, v20, v3
    ds_read_b64 v[16:17], v2 offset:20
    ds_read_b64 v[18:19], v2 offset:28
    ds_read_b32 v20, v2 offset:36
    s_waitcnt lgkmcnt(0)
    s_waitcnt vmcnt(35)
    v_lshlrev_b32 v21, 16, v44
    v_and_b32 v3, 0xffff0000, v44
    v_fmac_f32 v8, v16, v21
    v_fmac_f32 v9, v16, v3
    v_lshlrev_b32 v21, 16, v45
    v_and_b32 v3, 0xffff0000, v45
    v_fmac_f32 v10, v16, v21
    v_fmac_f32 v11, v16, v3
    v_lshlrev_b32 v21, 16, v46
    v_and_b32 v3, 0xffff0000, v46
    v_fmac_f32 v12, v16, v21
    v_fmac_f32 v13, v16, v3
    v_lshlrev_b32 v21, 16, v47
    v_and_b32 v3, 0xffff0000, v47
    v_fmac_f32 v14, v16, v21
    v_fmac_f32 v15, v16, v3
    s_waitcnt vmcnt(34)
    v_lshlrev_b32 v21, 16, v48
    v_and_b32 v3, 0xffff0000, v48
    v_fmac_f32 v8, v17, v21
    v_fmac_f32 v9, v17, v3
    v_lshlrev_b32 v21, 16, v49
    v_and_b32 v3, 0xffff0000, v49
    v_fmac_f32 v10, v17, v21
    v_fmac_f32 v11, v17, v3
    v_lshlrev_b32 v21, 16, v50
    v_and_b32 v3, 0xffff0000, v50
    v_fmac_f32 v12, v17, v21
    v_fmac_f32 v13, v17, v3
    v_lshlrev_b32 v21, 16, v51
    v_and_b32 v3, 0xffff0000, v51
    v_fmac_f32 v14, v17, v21
    v_fmac_f32 v15, v17, v3
    s_waitcnt vmcnt(33)
    v_lshlrev_b32 v21, 16, v52
    v_and_b32 v3, 0xffff0000, v52
    v_fmac_f32 v8, v18, v21
    v_fmac_f32 v9, v18, v3
    v_lshlrev_b32 v21, 16, v53
    v_and_b32 v3, 0xffff0000, v53
    v_fmac_f32 v10, v18, v21
    v_fmac_f32 v11, v18, v3
    v_lshlrev_b32 v21, 16, v54
    v_and_b32 v3, 0xffff0000, v54
    v_fmac_f32 v12, v18, v21
    v_fmac_f32 v13, v18, v3
    v_lshlrev_b32 v21, 16, v55
    v_and_b32 v3, 0xffff0000, v55
    v_fmac_f32 v14, v18, v21
    v_fmac_f32 v15, v18, v3
    s_waitcnt vmcnt(32)
    v_lshlrev_b32 v21, 16, v56
    v_and_b32 v3, 0xffff0000, v56
    v_fmac_f32 v8, v19, v21
    v_fmac_f32 v9, v19, v3
    v_lshlrev_b32 v21, 16, v57
    v_and_b32 v3, 0xffff0000, v57
    v_fmac_f32 v10, v19, v21
    v_fmac_f32 v11, v19, v3
    v_lshlrev_b32 v21, 16, v58
    v_and_b32 v3, 0xffff0000, v58
    v_fmac_f32 v12, v19, v21
    v_fmac_f32 v13, v19, v3
    v_lshlrev_b32 v21, 16, v59
    v_and_b32 v3, 0xffff0000, v59
    v_fmac_f32 v14, v19, v21
    v_fmac_f32 v15, v19, v3
    s_waitcnt vmcnt(31)
    v_lshlrev_b32 v21, 16, v60
    v_and_b32 v3, 0xffff0000, v60
    v_fmac_f32 v8, v20, v21
    v_fmac_f32 v9, v20, v3
    v_lshlrev_b32 v21, 16, v61
    v_and_b32 v3, 0xffff0000, v61
    v_fmac_f32 v10, v20, v21
    v_fmac_f32 v11, v20, v3
    v_lshlrev_b32 v21, 16, v62
    v_and_b32 v3, 0xffff0000, v62
    v_fmac_f32 v12, v20, v21
    v_fmac_f32 v13, v20, v3
    v_lshlrev_b32 v21, 16, v63
    v_and_b32 v3, 0xffff0000, v63
    v_fmac_f32 v14, v20, v21
    v_fmac_f32 v15, v20, v3
    v_mov_b32 v16, v8
    v_mov_b32 v17, v9
    v_mov_b32 v18, v10
    v_mov_b32 v19, v11
    v_mov_b32 v20, v12
    v_mov_b32 v21, v13
    v_mov_b32 v2, v14
    v_mov_b32 v3, v15
    s_nop 1
    v_permlane16_swap_b32 v8, v16
    v_permlane16_swap_b32 v9, v17
    v_permlane16_swap_b32 v10, v18
    v_permlane16_swap_b32 v11, v19
    v_permlane16_swap_b32 v12, v20
    v_permlane16_swap_b32 v13, v21
    v_permlane16_swap_b32 v14, v2
    v_permlane16_swap_b32 v15, v3
    v_add_f32 v8, v8, v16
    v_add_f32 v9, v9, v17
    v_add_f32 v10, v10, v18
    v_add_f32 v11, v11, v19
    v_add_f32 v12, v12, v20
    v_add_f32 v13, v13, v21
    v_add_f32 v14, v14, v2
    v_add_f32 v15, v15, v3
    v_mov_b32 v16, v8
    v_mov_b32 v17, v9
    v_mov_b32 v18, v10
    v_mov_b32 v19, v11
    v_mov_b32 v20, v12
    v_mov_b32 v21, v13
    v_mov_b32 v2, v14
    v_mov_b32 v3, v15
    s_nop 1
    v_permlane32_swap_b32 v8, v16
    v_permlane32_swap_b32 v9, v17
    v_permlane32_swap_b32 v10, v18
    v_permlane32_swap_b32 v11, v19
    v_permlane32_swap_b32 v12, v20
    v_permlane32_swap_b32 v13, v21
    v_permlane32_swap_b32 v14, v2
    v_permlane32_swap_b32 v15, v3
    v_add_f32 v8, v8, v16
    v_add_f32 v9, v9, v17
    v_add_f32 v10, v10, v18
    v_add_f32 v11, v11, v19
    v_add_f32 v12, v12, v20
    v_add_f32 v13, v13, v21
    v_add_f32 v14, v14, v2
    v_add_f32 v15, v15, v3
    v_lshlrev_b32 v2, 5, v23
    v_add_u32 v2, s78, v2
    ds_write_b128 v2, v[8:11] offset:8192
    ds_write_b128 v2, v[12:15] offset:8208
    v_lshrrev_b32 v2, 3, v0
    v_mul_u32_u24 v2, 20, v2
    ds_read_b32 v8, v2 offset:0
    ds_read_b32 v13, v2 offset:4096
    ds_read_b32 v9, v2 offset:4
    ds_read_b32 v14, v2 offset:4100
    ds_read_b32 v10, v2 offset:8
    ds_read_b32 v15, v2 offset:4104
    ds_read_b32 v11, v2 offset:12
    ds_read_b32 v16, v2 offset:4108
    ds_read_b32 v12, v2 offset:16
    ds_read_b32 v17, v2 offset:4112
    v_mov_b32 v18, 0
    v_mov_b32 v19, 0
    v_mov_b32 v20, 0
    v_mov_b32 v21, 0
    s_waitcnt lgkmcnt(0)
    s_waitcnt vmcnt(26)
    v_lshlrev_b32 v2, 16, v104
    v_and_b32 v3, 0xffff0000, v104
    v_fmac_f32 v18, v8, v2
    v_fmac_f32 v19, v8, v3
    v_fmac_f32 v20, v13, v2
    v_fmac_f32 v21, v13, v3
    v_lshlrev_b32 v2, 16, v105
    v_and_b32 v3, 0xffff0000, v105
    v_fmac_f32 v18, v9, v2
    v_fmac_f32 v19, v9, v3
    v_fmac_f32 v20, v14, v2
    v_fmac_f32 v21, v14, v3
    v_lshlrev_b32 v2, 16, v106
    v_and_b32 v3, 0xffff0000, v106
    v_fmac_f32 v18, v10, v2
    v_fmac_f32 v19, v10, v3
    v_fmac_f32 v20, v15, v2
    v_fmac_f32 v21, v15, v3
    v_lshlrev_b32 v2, 16, v107
    v_and_b32 v3, 0xffff0000, v107
    v_fmac_f32 v18, v11, v2
    v_fmac_f32 v19, v11, v3
    v_fmac_f32 v20, v16, v2
    v_fmac_f32 v21, v16, v3
    v_lshlrev_b32 v2, 16, v108
    v_and_b32 v3, 0xffff0000, v108
    v_fmac_f32 v18, v12, v2
    v_fmac_f32 v19, v12, v3
    v_fmac_f32 v20, v17, v2
    v_fmac_f32 v21, v17, v3
    s_nop 1
    v_add_f32_dpp v18, v18, v18 row_ror:8 row_mask:0xf bank_mask:0xf
    v_add_f32_dpp v19, v19, v19 row_ror:8 row_mask:0xf bank_mask:0xf
    v_add_f32_dpp v20, v20, v20 row_ror:8 row_mask:0xf bank_mask:0xf
    v_add_f32_dpp v21, v21, v21 row_ror:8 row_mask:0xf bank_mask:0xf
    v_mov_b32 v8, v18
    v_mov_b32 v9, v19
    v_mov_b32 v10, v20
    v_mov_b32 v11, v21
    s_nop 1
    v_permlane16_swap_b32 v18, v8
    v_permlane16_swap_b32 v19, v9
    v_permlane16_swap_b32 v20, v10
    v_permlane16_swap_b32 v21, v11
    v_add_f32 v18, v18, v8
    v_add_f32 v19, v19, v9
    v_add_f32 v20, v20, v10
    v_add_f32 v21, v21, v11
    v_mov_b32 v8, v18
    v_mov_b32 v9, v19
    v_mov_b32 v10, v20
    v_mov_b32 v11, v21
    s_nop 1
    v_permlane32_swap_b32 v18, v8
    v_permlane32_swap_b32 v19, v9
    v_permlane32_swap_b32 v20, v10
    v_permlane32_swap_b32 v21, v11
    v_add_f32 v18, v18, v8
    v_add_f32 v19, v19, v9
    v_add_f32 v20, v20, v10
    v_add_f32 v21, v21, v11
    v_and_b32 v2, 7, v0
    v_lshlrev_b32 v2, 3, v2
    v_add_u32 v2, s79, v2
    ds_write_b64 v2, v[18:19] offset:16640
    ds_write_b64 v2, v[20:21] offset:16704
    s_waitcnt lgkmcnt(0)
    s_barrier
    s_cmp_ge_u32 s69, 2
    s_cbranch_scc1 Lq1_a
    v_lshlrev_b32 v2, 2, v0
    ds_read_b32 v8, v2 offset:8192
    ds_read_b32 v9, v2 offset:8704
    ds_read_b32 v10, v2 offset:9216
    ds_read_b32 v11, v2 offset:9728
    ds_read_b32 v12, v2 offset:10240
    ds_read_b32 v13, v2 offset:10752
    ds_read_b32 v14, v2 offset:11264
    ds_read_b32 v15, v2 offset:11776
    ds_read_b32 v16, v2 offset:12288
    ds_read_b32 v17, v2 offset:12800
    ds_read_b32 v18, v2 offset:13312
    ds_read_b32 v19, v2 offset:13824
    ds_read_b32 v20, v2 offset:14336
    ds_read_b32 v21, v2 offset:14848
    s_waitcnt lgkmcnt(0)
    v_add_f32 v8, v8, v9
    v_add_f32 v8, v8, v10
    v_add_f32 v8, v8, v11
    v_add_f32 v8, v8, v12
    v_add_f32 v8, v8, v13
    v_add_f32 v8, v8, v14
    v_add_f32 v8, v8, v15
    v_add_f32 v8, v8, v16
    v_add_f32 v8, v8, v17
    v_add_f32 v8, v8, v18
    v_add_f32 v8, v8, v19
    v_add_f32 v8, v8, v20
    v_add_f32 v8, v8, v21
    ds_read_b32 v9, v2 offset:15360
    ds_read_b32 v10, v2 offset:15872
    s_waitcnt lgkmcnt(0)
    v_add_f32 v8, v8, v9
    v_add_f32 v8, v8, v10
    v_cvt_pk_bf16_f32 v8, v8, v8
    v_lshlrev_b32 v2, 1, v0
    ds_write_b16 v2, v8 offset:16384
    s_branch Lq1_b
Lq1_a:
    s_cmp_lg_u32 s69, 2
    s_cbranch_scc1 Lq1_b
    v_and_b32 v2, 31, v0
    v_lshlrev_b32 v2, 2, v2
    ds_read_b32 v8, v2 offset:16640
    ds_read_b32 v9, v2 offset:16768
    ds_read_b32 v10, v2 offset:16896
    ds_read_b32 v11, v2 offset:17024
    ds_read_b32 v12, v2 offset:17152
    ds_read_b32 v13, v2 offset:17280
    ds_read_b32 v14, v2 offset:17408
    ds_read_b32 v15, v2 offset:17536
    ds_read_b32 v16, v2 offset:17664
    ds_read_b32 v17, v2 offset:17792
    ds_read_b32 v18, v2 offset:17920
    ds_read_b32 v19, v2 offset:18048
    ds_read_b32 v20, v2 offset:18176
    ds_read_b32 v21, v2 offset:18304
    s_waitcnt lgkmcnt(0)
    v_add_f32 v8, v8, v9
    v_add_f32 v8, v8, v10
    v_add_f32 v8, v8, v11
    v_add_f32 v8, v8, v12
    v_add_f32 v8, v8, v13
    v_add_f32 v8, v8, v14
    v_add_f32 v8, v8, v15
    v_add_f32 v8, v8, v16
    v_add_f32 v8, v8, v17
    v_add_f32 v8, v8, v18
    v_add_f32 v8, v8, v19
    v_add_f32 v8, v8, v20
    v_add_f32 v8, v8, v21
    ds_read_b32 v9, v2 offset:18432
    ds_read_b32 v10, v2 offset:18560
    s_waitcnt lgkmcnt(0)
    v_add_f32 v8, v8, v9
    v_add_f32 v8, v8, v10
    v_cvt_pk_bf16_f32 v8, v8, v8
    v_lshlrev_b32 v8, 16, v8
    v_mul_f32 v9, 0xbfb8aa3b, v8
    v_exp_f32 v9, v9
    s_nop 0
    v_add_f32 v9, 1.0, v9
    v_rcp_f32 v9, v9
    s_nop 0
    v_mul_f32 v8, v8, v9
    v_cvt_pk_bf16_f32 v8, v8, v8
    v_lshlrev_b32 v8, 16, v8
    ds_write_b32 v2, v8 offset:18688
Lq1_b:
    s_waitcnt lgkmcnt(0)
    s_barrier
    v_lshlrev_b32 v2, 4, v23
    ds_read_b128 v[4:7], v2 offset:16384
    v_mov_b32 v2, 0
    ds_read_b128 v[8:11], v2 offset:18688
    ds_read_b128 v[12:15], v2 offset:18704
    ds_read_b128 v[16:19], v2 offset:18720
    ds_read_b128 v[20:23], v2 offset:18736
    s_waitcnt lgkmcnt(0)
    s_waitcnt vmcnt(10)
    v_mov_b32 v104, 0
    v_mov_b32 v105, 0
    v_mov_b32 v106, 0
    v_mov_b32 v107, 0
    v_lshlrev_b32 v2, 16, v112
    v_and_b32 v3, 0xffff0000, v112
    v_fmac_f32 v104, v8, v2
    v_fmac_f32 v105, v8, v3
    v_lshlrev_b32 v2, 16, v113
    v_and_b32 v3, 0xffff0000, v113
    v_fmac_f32 v104, v9, v2
    v_fmac_f32 v105, v9, v3
    v_lshlrev_b32 v2, 16, v114
    v_and_b32 v3, 0xffff0000, v114
    v_fmac_f32 v104, v10, v2
    v_fmac_f32 v105, v10, v3
    v_lshlrev_b32 v2, 16, v115
    v_and_b32 v3, 0xffff0000, v115
    v_fmac_f32 v104, v11, v2
    v_fmac_f32 v105, v11, v3
    v_lshlrev_b32 v2, 16, v116
    v_and_b32 v3, 0xffff0000, v116
    v_fmac_f32 v104, v12, v2
    v_fmac_f32 v105, v12, v3
    v_lshlrev_b32 v2, 16, v117
    v_and_b32 v3, 0xffff0000, v117
    v_fmac_f32 v104, v13, v2
    v_fmac_f32 v105, v13, v3
    v_lshlrev_b32 v2, 16, v118
    v_and_b32 v3, 0xffff0000, v118
    v_fmac_f32 v104, v14, v2
    v_fmac_f32 v105, v14, v3
    v_lshlrev_b32 v2, 16, v119
    v_and_b32 v3, 0xffff0000, v119
    v_fmac_f32 v104, v15, v2
    v_fmac_f32 v105, v15, v3
    v_lshlrev_b32 v2, 16, v120
    v_and_b32 v3, 0xffff0000, v120
    v_fmac_f32 v104, v16, v2
    v_fmac_f32 v105, v16, v3
    v_lshlrev_b32 v2, 16, v121
    v_and_b32 v3, 0xffff0000, v121
    v_fmac_f32 v104, v17, v2
    v_fmac_f32 v105, v17, v3
    v_lshlrev_b32 v2, 16, v122
    v_and_b32 v3, 0xffff0000, v122
    v_fmac_f32 v104, v18, v2
    v_fmac_f32 v105, v18, v3
    v_lshlrev_b32 v2, 16, v123
    v_and_b32 v3, 0xffff0000, v123
    v_fmac_f32 v104, v19, v2
    v_fmac_f32 v105, v19, v3
    v_lshlrev_b32 v2, 16, v124
    v_and_b32 v3, 0xffff0000, v124
    v_fmac_f32 v104, v20, v2
    v_fmac_f32 v105, v20, v3
    v_lshlrev_b32 v2, 16, v125
    v_and_b32 v3, 0xffff0000, v125
    v_fmac_f32 v104, v21, v2
    v_fmac_f32 v105, v21, v3
    v_lshlrev_b32 v2, 16, v126
    v_and_b32 v3, 0xffff0000, v126
    v_fmac_f32 v104, v22, v2
    v_fmac_f32 v105, v22, v3
    v_lshlrev_b32 v2, 16, v127
    v_and_b32 v3, 0xffff0000, v127
    v_fmac_f32 v104, v23, v2
    v_fmac_f32 v105, v23, v3
    v_mov_b32 v2, 0
    ds_read_b128 v[8:11], v2 offset:18752
    ds_read_b128 v[12:15], v2 offset:18768
    ds_read_b128 v[16:19], v2 offset:18784
    ds_read_b128 v[20:23], v2 offset:18800
    s_waitcnt lgkmcnt(0)
    v_lshlrev_b32 v2, 16, v112
    v_and_b32 v3, 0xffff0000, v112
    v_fmac_f32 v106, v8, v2
    v_fmac_f32 v107, v8, v3
    v_lshlrev_b32 v2, 16, v113
    v_and_b32 v3, 0xffff0000, v113
    v_fmac_f32 v106, v9, v2
    v_fmac_f32 v107, v9, v3
    v_lshlrev_b32 v2, 16, v114
    v_and_b32 v3, 0xffff0000, v114
    v_fmac_f32 v106, v10, v2
    v_fmac_f32 v107, v10, v3
    v_lshlrev_b32 v2, 16, v115
    v_and_b32 v3, 0xffff0000, v115
    v_fmac_f32 v106, v11, v2
    v_fmac_f32 v107, v11, v3
    v_lshlrev_b32 v2, 16, v116
    v_and_b32 v3, 0xffff0000, v116
    v_fmac_f32 v106, v12, v2
    v_fmac_f32 v107, v12, v3
    v_lshlrev_b32 v2, 16, v117
    v_and_b32 v3, 0xffff0000, v117
    v_fmac_f32 v106, v13, v2
    v_fmac_f32 v107, v13, v3
    v_lshlrev_b32 v2, 16, v118
    v_and_b32 v3, 0xffff0000, v118
    v_fmac_f32 v106, v14, v2
    v_fmac_f32 v107, v14, v3
    v_lshlrev_b32 v2, 16, v119
    v_and_b32 v3, 0xffff0000, v119
    v_fmac_f32 v106, v15, v2
    v_fmac_f32 v107, v15, v3
    v_lshlrev_b32 v2, 16, v120
    v_and_b32 v3, 0xffff0000, v120
    v_fmac_f32 v106, v16, v2
    v_fmac_f32 v107, v16, v3
    v_lshlrev_b32 v2, 16, v121
    v_and_b32 v3, 0xffff0000, v121
    v_fmac_f32 v106, v17, v2
    v_fmac_f32 v107, v17, v3
    v_lshlrev_b32 v2, 16, v122
    v_and_b32 v3, 0xffff0000, v122
    v_fmac_f32 v106, v18, v2
    v_fmac_f32 v107, v18, v3
    v_lshlrev_b32 v2, 16, v123
    v_and_b32 v3, 0xffff0000, v123
    v_fmac_f32 v106, v19, v2
    v_fmac_f32 v107, v19, v3
    v_lshlrev_b32 v2, 16, v124
    v_and_b32 v3, 0xffff0000, v124
    v_fmac_f32 v106, v20, v2
    v_fmac_f32 v107, v20, v3
    v_lshlrev_b32 v2, 16, v125
    v_and_b32 v3, 0xffff0000, v125
    v_fmac_f32 v106, v21, v2
    v_fmac_f32 v107, v21, v3
    v_lshlrev_b32 v2, 16, v126
    v_and_b32 v3, 0xffff0000, v126
    v_fmac_f32 v106, v22, v2
    v_fmac_f32 v107, v22, v3
    v_lshlrev_b32 v2, 16, v127
    v_and_b32 v3, 0xffff0000, v127
    v_fmac_f32 v106, v23, v2
    v_fmac_f32 v107, v23, v3
    s_cmp_ge_u32 s69, 5
    s_cbranch_scc1 Ly2skip
    v_lshlrev_b32 v2, 3, v0
    v_add_u32 v2, s90, v2
    buffer_store_dwordx2 v[104:105], v2, s[64:67], 0 offen
    buffer_store_dwordx2 v[106:107], v2, s[64:67], 0 offen offset:2560
Ly2skip:
    s_nop 1
    s_waitcnt lgkmcnt(0)
    buffer_load_dwordx4 v[104:107], v1, s[40:43], s75 offen offset:2048 nt
    buffer_load_dwordx4 v[108:111], v1, s[40:43], s75 offen offset:3072 nt
    buffer_load_dwordx4 v[112:115], v1, s[40:43], s76 offen offset:0 nt
    buffer_load_dwordx4 v[116:119], v1, s[40:43], s76 offen offset:1024 nt
    buffer_load_dwordx4 v[120:123], v1, s[40:43], s76 offen offset:2048 nt
    buffer_load_dwordx4 v[124:127], v1, s[40:43], s76 offen offset:3072 nt
    buffer_load_dwordx4 v[24:27], v1, s[44:47], 0 offen offset:0 nt
    buffer_load_dwordx4 v[28:31], v1, s[44:47], 0 offen offset:1024 nt
    buffer_load_dwordx4 v[32:35], v1, s[44:47], 0 offen offset:2048 nt
    buffer_load_dwordx4 v[36:39], v1, s[44:47], 0 offen offset:3072 nt
    s_waitcnt vmcnt(16)
    v_dot2_f32_bf16 v40, v64, v4, 0
    v_dot2_f32_bf16 v41, v68, v4, 0
    v_dot2_f32_bf16 v42, v72, v4, 0
    v_dot2_f32_bf16 v43, v76, v4, 0
    v_dot2_f32_bf16 v40, v65, v5, v40
    v_dot2_f32_bf16 v41, v69, v5, v41
    v_dot2_f32_bf16 v42, v73, v5, v42
    v_dot2_f32_bf16 v43, v77, v5, v43
    v_dot2_f32_bf16 v40, v66, v6, v40
    v_dot2_f32_bf16 v41, v70, v6, v41
    v_dot2_f32_bf16 v42, v74, v6, v42
    v_dot2_f32_bf16 v43, v78, v6, v43
    v_dot2_f32_bf16 v40, v67, v7, v40
    v_dot2_f32_bf16 v41, v71, v7, v41
    v_dot2_f32_bf16 v42, v75, v7, v42
    v_dot2_f32_bf16 v43, v79, v7, v43
    s_nop 2
    v_add_f32_dpp v40, v40, v40 row_ror:8 row_mask:0xf bank_mask:0xf
    v_add_f32_dpp v41, v41, v41 row_ror:8 row_mask:0xf bank_mask:0xf
    v_add_f32_dpp v42, v42, v42 row_ror:8 row_mask:0xf bank_mask:0xf
    v_add_f32_dpp v43, v43, v43 row_ror:8 row_mask:0xf bank_mask:0xf
    s_nop 0
    v_add_f32_dpp v40, v40, v40 row_ror:4 row_mask:0xf bank_mask:0xf
    v_add_f32_dpp v41, v41, v41 row_ror:4 row_mask:0xf bank_mask:0xf
    v_add_f32_dpp v42, v42, v42 row_ror:4 row_mask:0xf bank_mask:0xf
    v_add_f32_dpp v43, v43, v43 row_ror:4 row_mask:0xf bank_mask:0xf
    s_nop 0
    v_add_f32_dpp v40, v40, v40 row_ror:2 row_mask:0xf bank_mask:0xf
    v_add_f32_dpp v41, v41, v41 row_ror:2 row_mask:0xf bank_mask:0xf
    v_add_f32_dpp v42, v42, v42 row_ror:2 row_mask:0xf bank_mask:0xf
    v_add_f32_dpp v43, v43, v43 row_ror:2 row_mask:0xf bank_mask:0xf
    s_nop 0
    v_add_f32_dpp v40, v40, v40 row_ror:1 row_mask:0xf bank_mask:0xf
    v_add_f32_dpp v41, v41, v41 row_ror:1 row_mask:0xf bank_mask:0xf
    v_add_f32_dpp v42, v42, v42 row_ror:1 row_mask:0xf bank_mask:0xf
    v_add_f32_dpp v43, v43, v43 row_ror:1 row_mask:0xf bank_mask:0xf
    s_waitcnt vmcnt(12)
    v_dot2_f32_bf16 v44, v80, v4, 0
    v_dot2_f32_bf16 v45, v84, v4, 0
    v_dot2_f32_bf16 v46, v88, v4, 0
    v_dot2_f32_bf16 v47, v92, v4, 0
    v_dot2_f32_bf16 v44, v81, v5, v44
    v_dot2_f32_bf16 v45, v85, v5, v45
    v_dot2_f32_bf16 v46, v89, v5, v46
    v_dot2_f32_bf16 v47, v93, v5, v47
    v_dot2_f32_bf16 v44, v82, v6, v44
    v_dot2_f32_bf16 v45, v86, v6, v45
    v_dot2_f32_bf16 v46, v90, v6, v46
    v_dot2_f32_bf16 v47, v94, v6, v47
    v_dot2_f32_bf16 v44, v83, v7, v44
    v_dot2_f32_bf16 v45, v87, v7, v45
    v_dot2_f32_bf16 v46, v91, v7, v46
    v_dot2_f32_bf16 v47, v95, v7, v47
    s_nop 2
    v_add_f32_dpp v44, v44, v44 row_ror:8 row_mask:0xf bank_mask:0xf
    v_add_f32_dpp v45, v45, v45 row_ror:8 row_mask:0xf bank_mask:0xf
    v_add_f32_dpp v46, v46, v46 row_ror:8 row_mask:0xf bank_mask:0xf
    v_add_f32_dpp v47, v47, v47 row_ror:8 row_mask:0xf bank_mask:0xf
    s_nop 0
    v_add_f32_dpp v44, v44, v44 row_ror:4 row_mask:0xf bank_mask:0xf
    v_add_f32_dpp v45, v45, v45 row_ror:4 row_mask:0xf bank_mask:0xf
    v_add_f32_dpp v46, v46, v46 row_ror:4 row_mask:0xf bank_mask:0xf
    v_add_f32_dpp v47, v47, v47 row_ror:4 row_mask:0xf bank_mask:0xf
    s_nop 0
    v_add_f32_dpp v44, v44, v44 row_ror:2 row_mask:0xf bank_mask:0xf
    v_add_f32_dpp v45, v45, v45 row_ror:2 row_mask:0xf bank_mask:0xf
    v_add_f32_dpp v46, v46, v46 row_ror:2 row_mask:0xf bank_mask:0xf
    v_add_f32_dpp v47, v47, v47 row_ror:2 row_mask:0xf bank_mask:0xf
    s_nop 0
    v_add_f32_dpp v44, v44, v44 row_ror:1 row_mask:0xf bank_mask:0xf
    v_add_f32_dpp v45, v45, v45 row_ror:1 row_mask:0xf bank_mask:0xf
    v_add_f32_dpp v46, v46, v46 row_ror:1 row_mask:0xf bank_mask:0xf
    v_add_f32_dpp v47, v47, v47 row_ror:1 row_mask:0xf bank_mask:0xf
    s_waitcnt vmcnt(8)
    v_dot2_f32_bf16 v48, v96, v4, 0
    v_dot2_f32_bf16 v49, v100, v4, 0
    v_dot2_f32_bf16 v50, v104, v4, 0
    v_dot2_f32_bf16 v51, v108, v4, 0
    v_dot2_f32_bf16 v48, v97, v5, v48
    v_dot2_f32_bf16 v49, v101, v5, v49
    v_dot2_f32_bf16 v50, v105, v5, v50
    v_dot2_f32_bf16 v51, v109, v5, v51
    v_dot2_f32_bf16 v48, v98, v6, v48
    v_dot2_f32_bf16 v49, v102, v6, v49
    v_dot2_f32_bf16 v50, v106, v6, v50
    v_dot2_f32_bf16 v51, v110, v6, v51
    v_dot2_f32_bf16 v48, v99, v7, v48
    v_dot2_f32_bf16 v49, v103, v7, v49
    v_dot2_f32_bf16 v50, v107, v7, v50
    v_dot2_f32_bf16 v51, v111, v7, v51
    s_nop 2
    v_add_f32_dpp v48, v48, v48 row_ror:8 row_mask:0xf bank_mask:0xf
    v_add_f32_dpp v49, v49, v49 row_ror:8 row_mask:0xf bank_mask:0xf
    v_add_f32_dpp v50, v50, v50 row_ror:8 row_mask:0xf bank_mask:0xf
    v_add_f32_dpp v51, v51, v51 row_ror:8 row_mask:0xf bank_mask:0xf
    s_nop 0
    v_add_f32_dpp v48, v48, v48 row_ror:4 row_mask:0xf bank_mask:0xf
    v_add_f32_dpp v49, v49, v49 row_ror:4 row_mask:0xf bank_mask:0xf
    v_add_f32_dpp v50, v50, v50 row_ror:4 row_mask:0xf bank_mask:0xf
    v_add_f32_dpp v51, v51, v51 row_ror:4 row_mask:0xf bank_mask:0xf
    s_nop 0
    v_add_f32_dpp v48, v48, v48 row_ror:2 row_mask:0xf bank_mask:0xf
    v_add_f32_dpp v49, v49, v49 row_ror:2 row_mask:0xf bank_mask:0xf
    v_add_f32_dpp v50, v50, v50 row_ror:2 row_mask:0xf bank_mask:0xf
    v_add_f32_dpp v51, v51, v51 row_ror:2 row_mask:0xf bank_mask:0xf
    s_nop 0
    v_add_f32_dpp v48, v48, v48 row_ror:1 row_mask:0xf bank_mask:0xf
    v_add_f32_dpp v49, v49, v49 row_ror:1 row_mask:0xf bank_mask:0xf
    v_add_f32_dpp v50, v50, v50 row_ror:1 row_mask:0xf bank_mask:0xf
    v_add_f32_dpp v51, v51, v51 row_ror:1 row_mask:0xf bank_mask:0xf
    s_waitcnt vmcnt(4)
    v_dot2_f32_bf16 v52, v112, v4, 0
    v_dot2_f32_bf16 v53, v116, v4, 0
    v_dot2_f32_bf16 v54, v120, v4, 0
    v_dot2_f32_bf16 v55, v124, v4, 0
    v_dot2_f32_bf16 v52, v113, v5, v52
    v_dot2_f32_bf16 v53, v117, v5, v53
    v_dot2_f32_bf16 v54, v121, v5, v54
    v_dot2_f32_bf16 v55, v125, v5, v55
    v_dot2_f32_bf16 v52, v114, v6, v52
    v_dot2_f32_bf16 v53, v118, v6, v53
    v_dot2_f32_bf16 v54, v122, v6, v54
    v_dot2_f32_bf16 v55, v126, v6, v55
    v_dot2_f32_bf16 v52, v115, v7, v52
    v_dot2_f32_bf16 v53, v119, v7, v53
    v_dot2_f32_bf16 v54, v123, v7, v54
    v_dot2_f32_bf16 v55, v127, v7, v55
    s_nop 2
    v_add_f32_dpp v52, v52, v52 row_ror:8 row_mask:0xf bank_mask:0xf
    v_add_f32_dpp v53, v53, v53 row_ror:8 row_mask:0xf bank_mask:0xf
    v_add_f32_dpp v54, v54, v54 row_ror:8 row_mask:0xf bank_mask:0xf
    v_add_f32_dpp v55, v55, v55 row_ror:8 row_mask:0xf bank_mask:0xf
    s_nop 0
    v_add_f32_dpp v52, v52, v52 row_ror:4 row_mask:0xf bank_mask:0xf
    v_add_f32_dpp v53, v53, v53 row_ror:4 row_mask:0xf bank_mask:0xf
    v_add_f32_dpp v54, v54, v54 row_ror:4 row_mask:0xf bank_mask:0xf
    v_add_f32_dpp v55, v55, v55 row_ror:4 row_mask:0xf bank_mask:0xf
    s_nop 0
    v_add_f32_dpp v52, v52, v52 row_ror:2 row_mask:0xf bank_mask:0xf
    v_add_f32_dpp v53, v53, v53 row_ror:2 row_mask:0xf bank_mask:0xf
    v_add_f32_dpp v54, v54, v54 row_ror:2 row_mask:0xf bank_mask:0xf
    v_add_f32_dpp v55, v55, v55 row_ror:2 row_mask:0xf bank_mask:0xf
    s_nop 0
    v_add_f32_dpp v52, v52, v52 row_ror:1 row_mask:0xf bank_mask:0xf
    v_add_f32_dpp v53, v53, v53 row_ror:1 row_mask:0xf bank_mask:0xf
    v_add_f32_dpp v54, v54, v54 row_ror:1 row_mask:0xf bank_mask:0xf
    v_add_f32_dpp v55, v55, v55 row_ror:1 row_mask:0xf bank_mask:0xf
    buffer_load_dwordx4 v[64:67], v1, s[44:47], s74 offen offset:0 nt
    buffer_load_dwordx4 v[68:71], v1, s[44:47], s74 offen offset:1024 nt
    buffer_load_dwordx4 v[72:75], v1, s[44:47], s74 offen offset:2048 nt
    buffer_load_dwordx4 v[76:79], v1, s[44:47], s74 offen offset:3072 nt
    buffer_load_dwordx4 v[80:83], v1, s[44:47], s75 offen offset:0 nt
    buffer_load_dwordx4 v[84:87], v1, s[44:47], s75 offen offset:1024 nt
    buffer_load_dwordx4 v[88:91], v1, s[44:47], s75 offen offset:2048 nt
    buffer_load_dwordx4 v[92:95], v1, s[44:47], s75 offen offset:3072 nt
    buffer_load_dwordx4 v[96:99], v1, s[44:47], s76 offen offset:0 nt
    buffer_load_dwordx4 v[100:103], v1, s[44:47], s76 offen offset:1024 nt
    buffer_load_dwordx4 v[104:107], v1, s[44:47], s76 offen offset:2048 nt
    buffer_load_dwordx4 v[108:111], v1, s[44:47], s76 offen offset:3072 nt
    v_mov_b32 v3, 52429
    v_mul_u32_u24 v2, v0, v3
    v_lshrrev_b32 v22, 22, v2
    v_mul_u32_u24 v3, 80, v22
    v_sub_u32 v23, v0, v3
    v_mov_b32 v3, 1280
    v_mul_u32_u24 v21, v22, v3
    v_lshl_add_u32 v21, v23, 4, v21
    v_add_u32 v2, 0, v21
    buffer_load_dwordx4 v[112:115], v2, s[52:55], 0 offen
    v_add_u32 v2, 15360, v21
    buffer_load_dwordx4 v[116:119], v2, s[52:55], 0 offen
    v_add_u32 v2, 30720, v21
    buffer_load_dwordx4 v[120:123], v2, s[52:55], 0 offen
    v_add_u32 v2, 46080, v21
    buffer_load_dwordx4 v[124:127], v2, s[52:55], 0 offen
    v_cvt_pk_bf16_f32 v2, v40, v41
    v_lshlrev_b32 v40, 16, v2
    v_and_b32 v41, 0xffff0000, v2
    v_cvt_pk_bf16_f32 v2, v42, v43
    v_lshlrev_b32 v42, 16, v2
    v_and_b32 v43, 0xffff0000, v2
    v_cvt_pk_bf16_f32 v2, v44, v45
    v_lshlrev_b32 v44, 16, v2
    v_and_b32 v45, 0xffff0000, v2
    v_cvt_pk_bf16_f32 v2, v46, v47
    v_lshlrev_b32 v46, 16, v2
    v_and_b32 v47, 0xffff0000, v2
    v_cvt_pk_bf16_f32 v2, v48, v49
    v_lshlrev_b32 v48, 16, v2
    v_and_b32 v49, 0xffff0000, v2
    v_cvt_pk_bf16_f32 v2, v50, v51
    v_lshlrev_b32 v50, 16, v2
    v_and_b32 v51, 0xffff0000, v2
    v_cvt_pk_bf16_f32 v2, v52, v53
    v_lshlrev_b32 v52, 16, v2
    v_and_b32 v53, 0xffff0000, v2
    v_cvt_pk_bf16_f32 v2, v54, v55
    v_lshlrev_b32 v54, 16, v2
    v_and_b32 v55, 0xffff0000, v2
    v_mul_f32 v40, 0x3db504f3, v40
    v_mul_f32 v41, 0x3db504f3, v41
    v_mul_f32 v42, 0x3db504f3, v42
    v_mul_f32 v43, 0x3db504f3, v43
    v_mul_f32 v44, 0x3db504f3, v44
    v_mul_f32 v45, 0x3db504f3, v45
    v_mul_f32 v46, 0x3db504f3, v46
    v_mul_f32 v47, 0x3db504f3, v47
    v_mul_f32 v48, 0x3db504f3, v48
    v_mul_f32 v49, 0x3db504f3, v49
    v_mul_f32 v50, 0x3db504f3, v50
    v_mul_f32 v51, 0x3db504f3, v51
    v_mul_f32 v52, 0x3db504f3, v52
    v_mul_f32 v53, 0x3db504f3, v53
    v_mul_f32 v54, 0x3db504f3, v54
    v_mul_f32 v55, 0x3db504f3, v55
    v_cvt_pk_bf16_f32 v2, v40, v41
    v_lshlrev_b32 v40, 16, v2
    v_and_b32 v41, 0xffff0000, v2
    v_cvt_pk_bf16_f32 v2, v42, v43
    v_lshlrev_b32 v42, 16, v2
    v_and_b32 v43, 0xffff0000, v2
    v_cvt_pk_bf16_f32 v2, v44, v45
    v_lshlrev_b32 v44, 16, v2
    v_and_b32 v45, 0xffff0000, v2
    v_cvt_pk_bf16_f32 v2, v46, v47
    v_lshlrev_b32 v46, 16, v2
    v_and_b32 v47, 0xffff0000, v2
    v_cvt_pk_bf16_f32 v2, v48, v49
    v_lshlrev_b32 v48, 16, v2
    v_and_b32 v49, 0xffff0000, v2
    v_cvt_pk_bf16_f32 v2, v50, v51
    v_lshlrev_b32 v50, 16, v2
    v_and_b32 v51, 0xffff0000, v2
    v_cvt_pk_bf16_f32 v2, v52, v53
    v_lshlrev_b32 v52, 16, v2
    v_and_b32 v53, 0xffff0000, v2
    v_cvt_pk_bf16_f32 v2, v54, v55
    v_lshlrev_b32 v54, 16, v2
    v_and_b32 v55, 0xffff0000, v2
    v_max3_f32 v16, v40, v41, v42
    v_max3_f32 v16, v16, v43, v44
    v_max3_f32 v16, v16, v45, v46
    v_max3_f32 v16, v16, v47, v48
    v_max3_f32 v16, v16, v49, v50
    v_max3_f32 v16, v16, v51, v52
    v_max3_f32 v16, v16, v53, v54
    v_max_f32 v16, v16, v55
    v_mul_f32 v17, 0xbfb8aa3b, v16
    s_mov_b32 s91, 0x3fb8aa3b
    v_fma_f32 v40, v40, s91, v17
    v_fma_f32 v41, v41, s91, v17
    v_fma_f32 v42, v42, s91, v17
    v_fma_f32 v43, v43, s91, v17
    v_fma_f32 v44, v44, s91, v17
    v_fma_f32 v45, v45, s91, v17
    v_fma_f32 v46, v46, s91, v17
    v_fma_f32 v47, v47, s91, v17
    v_fma_f32 v48, v48, s91, v17
    v_fma_f32 v49, v49, s91, v17
    v_fma_f32 v50, v50, s91, v17
    v_fma_f32 v51, v51, s91, v17
    v_fma_f32 v52, v52, s91, v17
    v_fma_f32 v53, v53, s91, v17
    v_fma_f32 v54, v54, s91, v17
    v_fma_f32 v55, v55, s91, v17
    v_exp_f32 v40, v40
    v_exp_f32 v41, v41
    v_exp_f32 v42, v42
    v_exp_f32 v43, v43
    v_exp_f32 v44, v44
    v_exp_f32 v45, v45
    v_exp_f32 v46, v46
    v_exp_f32 v47, v47
    v_exp_f32 v48, v48
    v_exp_f32 v49, v49
    v_exp_f32 v50, v50
    v_exp_f32 v51, v51
    v_exp_f32 v52, v52
    v_exp_f32 v53, v53
    v_exp_f32 v54, v54
    v_exp_f32 v55, v55
    s_nop 0
    v_add_f32 v18, v40, v41
    v_add_f32 v18, v18, v42
    v_add_f32 v18, v18, v43
    v_add_f32 v18, v18, v44
    v_add_f32 v18, v18, v45
    v_add_f32 v18, v18, v46
    v_add_f32 v18, v18, v47
    v_add_f32 v18, v18, v48
    v_add_f32 v18, v18, v49
    v_add_f32 v18, v18, v50
    v_add_f32 v18, v18, v51
    v_add_f32 v18, v18, v52
    v_add_f32 v18, v18, v53
    v_add_f32 v18, v18, v54
    v_add_f32 v18, v18, v55
    v_mov_b32 v56, 0
    v_mov_b32 v57, 0
    v_mov_b32 v58, 0
    v_mov_b32 v59, 0
    v_mov_b32 v60, 0
    v_mov_b32 v61, 0
    v_mov_b32 v62, 0
    v_mov_b32 v63, 0
    s_waitcnt vmcnt(19)
    v_lshlrev_b32 v19, 16, v24
    v_and_b32 v20, 0xffff0000, v24
    v_fmac_f32 v56, v40, v19
    v_fmac_f32 v57, v40, v20
    v_lshlrev_b32 v19, 16, v25
    v_and_b32 v20, 0xffff0000, v25
    v_fmac_f32 v58, v40, v19
    v_fmac_f32 v59, v40, v20
    v_lshlrev_b32 v19, 16, v26
    v_and_b32 v20, 0xffff0000, v26
    v_fmac_f32 v60, v40, v19
    v_fmac_f32 v61, v40, v20
    v_lshlrev_b32 v19, 16, v27
    v_and_b32 v20, 0xffff0000, v27
    v_fmac_f32 v62, v40, v19
    v_fmac_f32 v63, v40, v20
    v_add_u32 v2, 61440, v21
    buffer_load_dwordx4 v[24:27], v2, s[52:55], 0 offen
    s_waitcnt vmcnt(19)
    v_lshlrev_b32 v19, 16, v28
    v_and_b32 v20, 0xffff0000, v28
    v_fmac_f32 v56, v41, v19
    v_fmac_f32 v57, v41, v20
    v_lshlrev_b32 v19, 16, v29
    v_and_b32 v20, 0xffff0000, v29
    v_fmac_f32 v58, v41, v19
    v_fmac_f32 v59, v41, v20
    v_lshlrev_b32 v19, 16, v30
    v_and_b32 v20, 0xffff0000, v30
    v_fmac_f32 v60, v41, v19
    v_fmac_f32 v61, v41, v20
    v_lshlrev_b32 v19, 16, v31
    v_and_b32 v20, 0xffff0000, v31
    v_fmac_f32 v62, v41, v19
    v_fmac_f32 v63, v41, v20
    v_add_u32 v2, 76800, v21
    buffer_load_dwordx4 v[28:31], v2, s[52:55], 0 offen
    s_waitcnt vmcnt(19)
    v_lshlrev_b32 v19, 16, v32
    v_and_b32 v20, 0xffff0000, v32
    v_fmac_f32 v56, v42, v19
    v_fmac_f32 v57, v42, v20
    v_lshlrev_b32 v19, 16, v33
    v_and_b32 v20, 0xffff0000, v33
    v_fmac_f32 v58, v42, v19
    v_fmac_f32 v59, v42, v20
    v_lshlrev_b32 v19, 16, v34
    v_and_b32 v20, 0xffff0000, v34
    v_fmac_f32 v60, v42, v19
    v_fmac_f32 v61, v42, v20
    v_lshlrev_b32 v19, 16, v35
    v_and_b32 v20, 0xffff0000, v35
    v_fmac_f32 v62, v42, v19
    v_fmac_f32 v63, v42, v20
    v_add_u32 v2, 92160, v21
    buffer_load_dwordx4 v[32:35], v2, s[52:55], 0 offen
    s_waitcnt vmcnt(19)
    v_lshlrev_b32 v19, 16, v36
    v_and_b32 v20, 0xffff0000, v36
    v_fmac_f32 v56, v43, v19
    v_fmac_f32 v57, v43, v20
    v_lshlrev_b32 v19, 16, v37
    v_and_b32 v20, 0xffff0000, v37
    v_fmac_f32 v58, v43, v19
    v_fmac_f32 v59, v43, v20
    v_lshlrev_b32 v19, 16, v38
    v_and_b32 v20, 0xffff0000, v38
    v_fmac_f32 v60, v43, v19
    v_fmac_f32 v61, v43, v20
    v_lshlrev_b32 v19, 16, v39
    v_and_b32 v20, 0xffff0000, v39
    v_fmac_f32 v62, v43, v19
    v_fmac_f32 v63, v43, v20
    v_add_u32 v2, 107520, v21
    buffer_load_dwordx4 v[36:39], v2, s[52:55], 0 offen
    s_waitcnt vmcnt(19)
    v_lshlrev_b32 v19, 16, v64
    v_and_b32 v20, 0xffff0000, v64
    v_fmac_f32 v56, v44, v19
    v_fmac_f32 v57, v44, v20
    v_lshlrev_b32 v19, 16, v65
    v_and_b32 v20, 0xffff0000, v65
    v_fmac_f32 v58, v44, v19
    v_fmac_f32 v59, v44, v20
    v_lshlrev_b32 v19, 16, v66
    v_and_b32 v20, 0xffff0000, v66
    v_fmac_f32 v60, v44, v19
    v_fmac_f32 v61, v44, v20
    v_lshlrev_b32 v19, 16, v67
    v_and_b32 v20, 0xffff0000, v67
    v_fmac_f32 v62, v44, v19
    v_fmac_f32 v63, v44, v20
    v_add_u32 v2, 122880, v21
    buffer_load_dwordx4 v[64:67], v2, s[52:55], 0 offen
    s_waitcnt vmcnt(19)
    v_lshlrev_b32 v19, 16, v68
    v_and_b32 v20, 0xffff0000, v68
    v_fmac_f32 v56, v45, v19
    v_fmac_f32 v57, v45, v20
    v_lshlrev_b32 v19, 16, v69
    v_and_b32 v20, 0xffff0000, v69
    v_fmac_f32 v58, v45, v19
    v_fmac_f32 v59, v45, v20
    v_lshlrev_b32 v19, 16, v70
    v_and_b32 v20, 0xffff0000, v70
    v_fmac_f32 v60, v45, v19
    v_fmac_f32 v61, v45, v20
    v_lshlrev_b32 v19, 16, v71
    v_and_b32 v20, 0xffff0000, v71
    v_fmac_f32 v62, v45, v19
    v_fmac_f32 v63, v45, v20
    v_add_u32 v2, 138240, v21
    buffer_load_dwordx4 v[68:71], v2, s[52:55], 0 offen
    s_waitcnt vmcnt(19)
    v_lshlrev_b32 v19, 16, v72
    v_and_b32 v20, 0xffff0000, v72
    v_fmac_f32 v56, v46, v19
    v_fmac_f32 v57, v46, v20
    v_lshlrev_b32 v19, 16, v73
    v_and_b32 v20, 0xffff0000, v73
    v_fmac_f32 v58, v46, v19
    v_fmac_f32 v59, v46, v20
    v_lshlrev_b32 v19, 16, v74
    v_and_b32 v20, 0xffff0000, v74
    v_fmac_f32 v60, v46, v19
    v_fmac_f32 v61, v46, v20
    v_lshlrev_b32 v19, 16, v75
    v_and_b32 v20, 0xffff0000, v75
    v_fmac_f32 v62, v46, v19
    v_fmac_f32 v63, v46, v20
    v_add_u32 v2, 153600, v21
    buffer_load_dwordx4 v[72:75], v2, s[52:55], 0 offen
    s_waitcnt vmcnt(19)
    v_lshlrev_b32 v19, 16, v76
    v_and_b32 v20, 0xffff0000, v76
    v_fmac_f32 v56, v47, v19
    v_fmac_f32 v57, v47, v20
    v_lshlrev_b32 v19, 16, v77
    v_and_b32 v20, 0xffff0000, v77
    v_fmac_f32 v58, v47, v19
    v_fmac_f32 v59, v47, v20
    v_lshlrev_b32 v19, 16, v78
    v_and_b32 v20, 0xffff0000, v78
    v_fmac_f32 v60, v47, v19
    v_fmac_f32 v61, v47, v20
    v_lshlrev_b32 v19, 16, v79
    v_and_b32 v20, 0xffff0000, v79
    v_fmac_f32 v62, v47, v19
    v_fmac_f32 v63, v47, v20
    s_waitcnt vmcnt(18)
    v_lshlrev_b32 v19, 16, v80
    v_and_b32 v20, 0xffff0000, v80
    v_fmac_f32 v56, v48, v19
    v_fmac_f32 v57, v48, v20
    v_lshlrev_b32 v19, 16, v81
    v_and_b32 v20, 0xffff0000, v81
    v_fmac_f32 v58, v48, v19
    v_fmac_f32 v59, v48, v20
    v_lshlrev_b32 v19, 16, v82
    v_and_b32 v20, 0xffff0000, v82
    v_fmac_f32 v60, v48, v19
    v_fmac_f32 v61, v48, v20
    v_lshlrev_b32 v19, 16, v83
    v_and_b32 v20, 0xffff0000, v83
    v_fmac_f32 v62, v48, v19
    v_fmac_f32 v63, v48, v20
    s_waitcnt vmcnt(17)
    v_lshlrev_b32 v19, 16, v84
    v_and_b32 v20, 0xffff0000, v84
    v_fmac_f32 v56, v49, v19
    v_fmac_f32 v57, v49, v20
    v_lshlrev_b32 v19, 16, v85
    v_and_b32 v20, 0xffff0000, v85
    v_fmac_f32 v58, v49, v19
    v_fmac_f32 v59, v49, v20
    v_lshlrev_b32 v19, 16, v86
    v_and_b32 v20, 0xffff0000, v86
    v_fmac_f32 v60, v49, v19
    v_fmac_f32 v61, v49, v20
    v_lshlrev_b32 v19, 16, v87
    v_and_b32 v20, 0xffff0000, v87
    v_fmac_f32 v62, v49, v19
    v_fmac_f32 v63, v49, v20
    s_waitcnt vmcnt(16)
    v_lshlrev_b32 v19, 16, v88
    v_and_b32 v20, 0xffff0000, v88
    v_fmac_f32 v56, v50, v19
    v_fmac_f32 v57, v50, v20
    v_lshlrev_b32 v19, 16, v89
    v_and_b32 v20, 0xffff0000, v89
    v_fmac_f32 v58, v50, v19
    v_fmac_f32 v59, v50, v20
    v_lshlrev_b32 v19, 16, v90
    v_and_b32 v20, 0xffff0000, v90
    v_fmac_f32 v60, v50, v19
    v_fmac_f32 v61, v50, v20
    v_lshlrev_b32 v19, 16, v91
    v_and_b32 v20, 0xffff0000, v91
    v_fmac_f32 v62, v50, v19
    v_fmac_f32 v63, v50, v20
    s_waitcnt vmcnt(15)
    v_lshlrev_b32 v19, 16, v92
    v_and_b32 v20, 0xffff0000, v92
    v_fmac_f32 v56, v51, v19
    v_fmac_f32 v57, v51, v20
    v_lshlrev_b32 v19, 16, v93
    v_and_b32 v20, 0xffff0000, v93
    v_fmac_f32 v58, v51, v19
    v_fmac_f32 v59, v51, v20
    v_lshlrev_b32 v19, 16, v94
    v_and_b32 v20, 0xffff0000, v94
    v_fmac_f32 v60, v51, v19
    v_fmac_f32 v61, v51, v20
    v_lshlrev_b32 v19, 16, v95
    v_and_b32 v20, 0xffff0000, v95
    v_fmac_f32 v62, v51, v19
    v_fmac_f32 v63, v51, v20
    s_waitcnt vmcnt(14)
    v_lshlrev_b32 v19, 16, v96
    v_and_b32 v20, 0xffff0000, v96
    v_fmac_f32 v56, v52, v19
    v_fmac_f32 v57, v52, v20
    v_lshlrev_b32 v19, 16, v97
    v_and_b32 v20, 0xffff0000, v97
    v_fmac_f32 v58, v52, v19
    v_fmac_f32 v59, v52, v20
    v_lshlrev_b32 v19, 16, v98
    v_and_b32 v20, 0xffff0000, v98
    v_fmac_f32 v60, v52, v19
    v_fmac_f32 v61, v52, v20
    v_lshlrev_b32 v19, 16, v99
    v_and_b32 v20, 0xffff0000, v99
    v_fmac_f32 v62, v52, v19
    v_fmac_f32 v63, v52, v20
    s_waitcnt vmcnt(13)
    v_lshlrev_b32 v19, 16, v100
    v_and_b32 v20, 0xffff0000, v100
    v_fmac_f32 v56, v53, v19
    v_fmac_f32 v57, v53, v20
    v_lshlrev_b32 v19, 16, v101
    v_and_b32 v20, 0xffff0000, v101
    v_fmac_f32 v58, v53, v19
    v_fmac_f32 v59, v53, v20
    v_lshlrev_b32 v19, 16, v102
    v_and_b32 v20, 0xffff0000, v102
    v_fmac_f32 v60, v53, v19
    v_fmac_f32 v61, v53, v20
    v_lshlrev_b32 v19, 16, v103
    v_and_b32 v20, 0xffff0000, v103
    v_fmac_f32 v62, v53, v19
    v_fmac_f32 v63, v53, v20
    s_waitcnt vmcnt(12)
    v_lshlrev_b32 v19, 16, v104
    v_and_b32 v20, 0xffff0000, v104
    v_fmac_f32 v56, v54, v19
    v_fmac_f32 v57, v54, v20
    v_lshlrev_b32 v19, 16, v105
    v_and_b32 v20, 0xffff0000, v105
    v_fmac_f32 v58, v54, v19
    v_fmac_f32 v59, v54, v20
    v_lshlrev_b32 v19, 16, v106
    v_and_b32 v20, 0xffff0000, v106
    v_fmac_f32 v60, v54, v19
    v_fmac_f32 v61, v54, v20
    v_lshlrev_b32 v19, 16, v107
    v_and_b32 v20, 0xffff0000, v107
    v_fmac_f32 v62, v54, v19
    v_fmac_f32 v63, v54, v20
    s_waitcnt vmcnt(11)
    v_lshlrev_b32 v19, 16, v108
    v_and_b32 v20, 0xffff0000, v108
    v_fmac_f32 v56, v55, v19
    v_fmac_f32 v57, v55, v20
    v_lshlrev_b32 v19, 16, v109
    v_and_b32 v20, 0xffff0000, v109
    v_fmac_f32 v58, v55, v19
    v_fmac_f32 v59, v55, v20
    v_lshlrev_b32 v19, 16, v110
    v_and_b32 v20, 0xffff0000, v110
    v_fmac_f32 v60, v55, v19
    v_fmac_f32 v61, v55, v20
    v_lshlrev_b32 v19, 16, v111
    v_and_b32 v20, 0xffff0000, v111
    v_fmac_f32 v62, v55, v19
    v_fmac_f32 v63, v55, v20
    v_bfe_u32 v2, v0, 4, 6
    v_lshlrev_b32 v2, 2, v2
    ds_write_b32 v2, v16 offset:18816
    s_waitcnt lgkmcnt(0)
    s_barrier
    v_and_b32 v2, 63, v0
    v_lshlrev_b32 v2, 2, v2
    ds_read_b32 v17, v2 offset:18816
    s_waitcnt lgkmcnt(0)
    s_nop 0
    v_max_f32_dpp v17, v17, v17 row_ror:8 row_mask:0xf bank_mask:0xf
    s_nop 1
    v_max_f32_dpp v17, v17, v17 row_ror:4 row_mask:0xf bank_mask:0xf
    s_nop 1
    v_max_f32_dpp v17, v17, v17 row_ror:2 row_mask:0xf bank_mask:0xf
    s_nop 1
    v_max_f32_dpp v17, v17, v17 row_ror:1 row_mask:0xf bank_mask:0xf
    s_nop 1
    v_mov_b32 v19, v17
    s_nop 1
    v_permlane16_swap_b32 v17, v19
    v_max_f32 v17, v17, v19
    v_mov_b32 v19, v17
    s_nop 1
    v_permlane32_swap_b32 v17, v19
    v_max_f32 v17, v17, v19
    v_sub_f32 v19, v16, v17
    v_mul_f32 v19, 0x3fb8aa3b, v19
    v_exp_f32 v19, v19
    s_nop 0
    v_mul_f32 v56, v56, v19
    v_mul_f32 v57, v57, v19
    v_mul_f32 v58, v58, v19
    v_mul_f32 v59, v59, v19
    v_mul_f32 v60, v60, v19
    v_mul_f32 v61, v61, v19
    v_mul_f32 v62, v62, v19
    v_mul_f32 v63, v63, v19
    v_mul_f32 v18, v18, v19
    v_mov_b32 v40, v56
    v_mov_b32 v41, v57
    v_mov_b32 v42, v58
    v_mov_b32 v43, v59
    v_mov_b32 v44, v60
    v_mov_b32 v45, v61
    v_mov_b32 v46, v62
    v_mov_b32 v47, v63
    v_mov_b32 v48, v18
    s_nop 1
    v_permlane16_swap_b32 v56, v40
    v_permlane16_swap_b32 v57, v41
    v_permlane16_swap_b32 v58, v42
    v_permlane16_swap_b32 v59, v43
    v_permlane16_swap_b32 v60, v44
    v_permlane16_swap_b32 v61, v45
    v_permlane16_swap_b32 v62, v46
    v_permlane16_swap_b32 v63, v47
    v_permlane16_swap_b32 v18, v48
    v_add_f32 v56, v56, v40
    v_add_f32 v57, v57, v41
    v_add_f32 v58, v58, v42
    v_add_f32 v59, v59, v43
    v_add_f32 v60, v60, v44
    v_add_f32 v61, v61, v45
    v_add_f32 v62, v62, v46
    v_add_f32 v63, v63, v47
    v_add_f32 v18, v18, v48
    v_mov_b32 v40, v56
    v_mov_b32 v41, v57
    v_mov_b32 v42, v58
    v_mov_b32 v43, v59
    v_mov_b32 v44, v60
    v_mov_b32 v45, v61
    v_mov_b32 v46, v62
    v_mov_b32 v47, v63
    v_mov_b32 v48, v18
    s_nop 1
    v_permlane32_swap_b32 v56, v40
    v_permlane32_swap_b32 v57, v41
    v_permlane32_swap_b32 v58, v42
    v_permlane32_swap_b32 v59, v43
    v_permlane32_swap_b32 v60, v44
    v_permlane32_swap_b32 v61, v45
    v_permlane32_swap_b32 v62, v46
    v_permlane32_swap_b32 v63, v47
    v_permlane32_swap_b32 v18, v48
    v_add_f32 v56, v56, v40
    v_add_f32 v57, v57, v41
    v_add_f32 v58, v58, v42
    v_add_f32 v59, v59, v43
    v_add_f32 v60, v60, v44
    v_add_f32 v61, v61, v45
    v_add_f32 v62, v62, v46
    v_add_f32 v63, v63, v47
    v_add_f32 v18, v18, v48
    v_and_b32 v2, 15, v0
    v_lshlrev_b32 v2, 5, v2
    v_add_u32 v2, s78, v2
    ds_write_b128 v2, v[56:59] offset:20480
    ds_write_b128 v2, v[60:63] offset:20496
    v_mov_b32 v2, s69
    v_lshlrev_b32 v2, 2, v2
    ds_write_b32 v2, v18 offset:19072
    s_waitcnt lgkmcnt(0)
    s_barrier
    s_cmp_ge_u32 s69, 2
    s_cbranch_scc1 Lo1_a
    v_lshlrev_b32 v2, 2, v0
    ds_read_b32 v40, v2 offset:20480
    ds_read_b32 v41, v2 offset:20992
    ds_read_b32 v42, v2 offset:21504
    ds_read_b32 v43, v2 offset:22016
    ds_read_b32 v44, v2 offset:22528
    ds_read_b32 v45, v2 offset:23040
    ds_read_b32 v46, v2 offset:23552
    ds_read_b32 v47, v2 offset:24064
    ds_read_b32 v48, v2 offset:24576
    ds_read_b32 v49, v2 offset:25088
    ds_read_b32 v50, v2 offset:25600
    ds_read_b32 v51, v2 offset:26112
    ds_read_b32 v52, v2 offset:26624
    ds_read_b32 v53, v2 offset:27136
    ds_read_b32 v54, v2 offset:27648
    ds_read_b32 v55, v2 offset:28160
    s_waitcnt lgkmcnt(0)
    v_add_f32 v40, v40, v41
    v_add_f32 v40, v40, v42
    v_add_f32 v40, v40, v43
    v_add_f32 v40, v40, v44
    v_add_f32 v40, v40, v45
    v_add_f32 v40, v40, v46
    v_add_f32 v40, v40, v47
    v_add_f32 v40, v40, v48
    v_add_f32 v40, v40, v49
    v_add_f32 v40, v40, v50
    v_add_f32 v40, v40, v51
    v_add_f32 v40, v40, v52
    v_add_f32 v40, v40, v53
    v_add_f32 v40, v40, v54
    v_add_f32 v40, v40, v55
    ds_write_b32 v2, v40 offset:19200
    s_branch Lo1_b
Lo1_a:
    s_cmp_lg_u32 s69, 2
    s_cbranch_scc1 Lo1_c
    v_lshlrev_b32 v2, 2, v0
    v_mov_b32 v3, 0
    ds_write_b32 v2, v3 offset:19200
    s_branch Lo1_b
Lo1_c:
    s_cmp_lg_u32 s69, 3
    s_cbranch_scc1 Lo1_b
    v_mov_b32 v2, 0
    ds_read_b128 v[40:43], v2 offset:19072
    ds_read_b128 v[44:47], v2 offset:19088
    ds_read_b128 v[48:51], v2 offset:19104
    ds_read_b128 v[52:55], v2 offset:19120
    s_waitcnt lgkmcnt(0)
    v_add_f32 v40, v40, v41
    v_add_f32 v40, v40, v42
    v_add_f32 v40, v40, v43
    v_add_f32 v40, v40, v44
    v_add_f32 v40, v40, v45
    v_add_f32 v40, v40, v46
    v_add_f32 v40, v40, v47
    v_add_f32 v40, v40, v48
    v_add_f32 v40, v40, v49
    v_add_f32 v40, v40, v50
    v_add_f32 v40, v40, v51
    v_add_f32 v40, v40, v52
    v_add_f32 v40, v40, v53
    v_add_f32 v40, v40, v54
    v_add_f32 v40, v40, v55
    v_mov_b32 v41, v40
    v_mov_b32 v40, v17
    v_mov_b32 v2, s92
    buffer_store_dwordx2 v[40:41], v2, s[64:67], 0 offen
Lo1_b:
    s_waitcnt lgkmcnt(0)
    s_barrier
    v_lshlrev_b32 v2, 2, v22
    ds_read_b32 v40, v2 offset:19200
    ds_read_b32 v41, v2 offset:19248
    ds_read_b32 v42, v2 offset:19296
    ds_read_b32 v43, v2 offset:19344
    ds_read_b32 v44, v2 offset:19392
    ds_read_b32 v45, v2 offset:19440
    ds_read_b32 v46, v2 offset:19488
    ds_read_b32 v47, v2 offset:19536
    ds_read_b32 v48, v2 offset:19584
    ds_read_b32 v49, v2 offset:19632
    ds_read_b32 v50, v2 offset:19680
    v_mov_b32 v56, 0
    v_mov_b32 v57, 0
    v_mov_b32 v58, 0
    v_mov_b32 v59, 0
    v_mov_b32 v60, 0
    v_mov_b32 v61, 0
    v_mov_b32 v62, 0
    v_mov_b32 v63, 0
    s_waitcnt lgkmcnt(0)
    s_waitcnt vmcnt(10)
    v_lshlrev_b32 v19, 16, v112
    v_and_b32 v20, 0xffff0000, v112
    v_fmac_f32 v56, v40, v19
    v_fmac_f32 v57, v40, v20
    v_lshlrev_b32 v19, 16, v113
    v_and_b32 v20, 0xffff0000, v113
    v_fmac_f32 v58, v40, v19
    v_fmac_f32 v59, v40, v20
    v_lshlrev_b32 v19, 16, v114
    v_and_b32 v20, 0xffff0000, v114
    v_fmac_f32 v60, v40, v19
    v_fmac_f32 v61, v40, v20
    v_lshlrev_b32 v19, 16, v115
    v_and_b32 v20, 0xffff0000, v115
    v_fmac_f32 v62, v40, v19
    v_fmac_f32 v63, v40, v20
    s_waitcnt vmcnt(9)
    v_lshlrev_b32 v19, 16, v116
    v_and_b32 v20, 0xffff0000, v116
    v_fmac_f32 v56, v41, v19
    v_fmac_f32 v57, v41, v20
    v_lshlrev_b32 v19, 16, v117
    v_and_b32 v20, 0xffff0000, v117
    v_fmac_f32 v58, v41, v19
    v_fmac_f32 v59, v41, v20
    v_lshlrev_b32 v19, 16, v118
    v_and_b32 v20, 0xffff0000, v118
    v_fmac_f32 v60, v41, v19
    v_fmac_f32 v61, v41, v20
    v_lshlrev_b32 v19, 16, v119
    v_and_b32 v20, 0xffff0000, v119
    v_fmac_f32 v62, v41, v19
    v_fmac_f32 v63, v41, v20
    s_waitcnt vmcnt(8)
    v_lshlrev_b32 v19, 16, v120
    v_and_b32 v20, 0xffff0000, v120
    v_fmac_f32 v56, v42, v19
    v_fmac_f32 v57, v42, v20
    v_lshlrev_b32 v19, 16, v121
    v_and_b32 v20, 0xffff0000, v121
    v_fmac_f32 v58, v42, v19
    v_fmac_f32 v59, v42, v20
    v_lshlrev_b32 v19, 16, v122
    v_and_b32 v20, 0xffff0000, v122
    v_fmac_f32 v60, v42, v19
    v_fmac_f32 v61, v42, v20
    v_lshlrev_b32 v19, 16, v123
    v_and_b32 v20, 0xffff0000, v123
    v_fmac_f32 v62, v42, v19
    v_fmac_f32 v63, v42, v20
    s_waitcnt vmcnt(7)
    v_lshlrev_b32 v19, 16, v124
    v_and_b32 v20, 0xffff0000, v124
    v_fmac_f32 v56, v43, v19
    v_fmac_f32 v57, v43, v20
    v_lshlrev_b32 v19, 16, v125
    v_and_b32 v20, 0xffff0000, v125
    v_fmac_f32 v58, v43, v19
    v_fmac_f32 v59, v43, v20
    v_lshlrev_b32 v19, 16, v126
    v_and_b32 v20, 0xffff0000, v126
    v_fmac_f32 v60, v43, v19
    v_fmac_f32 v61, v43, v20
    v_lshlrev_b32 v19, 16, v127
    v_and_b32 v20, 0xffff0000, v127
    v_fmac_f32 v62, v43, v19
    v_fmac_f32 v63, v43, v20
    s_waitcnt vmcnt(6)
    v_lshlrev_b32 v19, 16, v24
    v_and_b32 v20, 0xffff0000, v24
    v_fmac_f32 v56, v44, v19
    v_fmac_f32 v57, v44, v20
    v_lshlrev_b32 v19, 16, v25
    v_and_b32 v20, 0xffff0000, v25
    v_fmac_f32 v58, v44, v19
    v_fmac_f32 v59, v44, v20
    v_lshlrev_b32 v19, 16, v26
    v_and_b32 v20, 0xffff0000, v26
    v_fmac_f32 v60, v44, v19
    v_fmac_f32 v61, v44, v20
    v_lshlrev_b32 v19, 16, v27
    v_and_b32 v20, 0xffff0000, v27
    v_fmac_f32 v62, v44, v19
    v_fmac_f32 v63, v44, v20
    s_waitcnt vmcnt(5)
    v_lshlrev_b32 v19, 16, v28
    v_and_b32 v20, 0xffff0000, v28
    v_fmac_f32 v56, v45, v19
    v_fmac_f32 v57, v45, v20
    v_lshlrev_b32 v19, 16, v29
    v_and_b32 v20, 0xffff0000, v29
    v_fmac_f32 v58, v45, v19
    v_fmac_f32 v59, v45, v20
    v_lshlrev_b32 v19, 16, v30
    v_and_b32 v20, 0xffff0000, v30
    v_fmac_f32 v60, v45, v19
    v_fmac_f32 v61, v45, v20
    v_lshlrev_b32 v19, 16, v31
    v_and_b32 v20, 0xffff0000, v31
    v_fmac_f32 v62, v45, v19
    v_fmac_f32 v63, v45, v20
    s_waitcnt vmcnt(4)
    v_lshlrev_b32 v19, 16, v32
    v_and_b32 v20, 0xffff0000, v32
    v_fmac_f32 v56, v46, v19
    v_fmac_f32 v57, v46, v20
    v_lshlrev_b32 v19, 16, v33
    v_and_b32 v20, 0xffff0000, v33
    v_fmac_f32 v58, v46, v19
    v_fmac_f32 v59, v46, v20
    v_lshlrev_b32 v19, 16, v34
    v_and_b32 v20, 0xffff0000, v34
    v_fmac_f32 v60, v46, v19
    v_fmac_f32 v61, v46, v20
    v_lshlrev_b32 v19, 16, v35
    v_and_b32 v20, 0xffff0000, v35
    v_fmac_f32 v62, v46, v19
    v_fmac_f32 v63, v46, v20
    s_waitcnt vmcnt(3)
    v_lshlrev_b32 v19, 16, v36
    v_and_b32 v20, 0xffff0000, v36
    v_fmac_f32 v56, v47, v19
    v_fmac_f32 v57, v47, v20
    v_lshlrev_b32 v19, 16, v37
    v_and_b32 v20, 0xffff0000, v37
    v_fmac_f32 v58, v47, v19
    v_fmac_f32 v59, v47, v20
    v_lshlrev_b32 v19, 16, v38
    v_and_b32 v20, 0xffff0000, v38
    v_fmac_f32 v60, v47, v19
    v_fmac_f32 v61, v47, v20
    v_lshlrev_b32 v19, 16, v39
    v_and_b32 v20, 0xffff0000, v39
    v_fmac_f32 v62, v47, v19
    v_fmac_f32 v63, v47, v20
    s_waitcnt vmcnt(2)
    v_lshlrev_b32 v19, 16, v64
    v_and_b32 v20, 0xffff0000, v64
    v_fmac_f32 v56, v48, v19
    v_fmac_f32 v57, v48, v20
    v_lshlrev_b32 v19, 16, v65
    v_and_b32 v20, 0xffff0000, v65
    v_fmac_f32 v58, v48, v19
    v_fmac_f32 v59, v48, v20
    v_lshlrev_b32 v19, 16, v66
    v_and_b32 v20, 0xffff0000, v66
    v_fmac_f32 v60, v48, v19
    v_fmac_f32 v61, v48, v20
    v_lshlrev_b32 v19, 16, v67
    v_and_b32 v20, 0xffff0000, v67
    v_fmac_f32 v62, v48, v19
    v_fmac_f32 v63, v48, v20
    s_waitcnt vmcnt(1)
    v_lshlrev_b32 v19, 16, v68
    v_and_b32 v20, 0xffff0000, v68
    v_fmac_f32 v56, v49, v19
    v_fmac_f32 v57, v49, v20
    v_lshlrev_b32 v19, 16, v69
    v_and_b32 v20, 0xffff0000, v69
    v_fmac_f32 v58, v49, v19
    v_fmac_f32 v59, v49, v20
    v_lshlrev_b32 v19, 16, v70
    v_and_b32 v20, 0xffff0000, v70
    v_fmac_f32 v60, v49, v19
    v_fmac_f32 v61, v49, v20
    v_lshlrev_b32 v19, 16, v71
    v_and_b32 v20, 0xffff0000, v71
    v_fmac_f32 v62, v49, v19
    v_fmac_f32 v63, v49, v20
    s_waitcnt vmcnt(0)
    v_lshlrev_b32 v19, 16, v72
    v_and_b32 v20, 0xffff0000, v72
    v_fmac_f32 v56, v50, v19
    v_fmac_f32 v57, v50, v20
    v_lshlrev_b32 v19, 16, v73
    v_and_b32 v20, 0xffff0000, v73
    v_fmac_f32 v58, v50, v19
    v_fmac_f32 v59, v50, v20
    v_lshlrev_b32 v19, 16, v74
    v_and_b32 v20, 0xffff0000, v74
    v_fmac_f32 v60, v50, v19
    v_fmac_f32 v61, v50, v20
    v_lshlrev_b32 v19, 16, v75
    v_and_b32 v20, 0xffff0000, v75
    v_fmac_f32 v62, v50, v19
    v_fmac_f32 v63, v50, v20
    v_mov_b32 v3, 2560
    v_mul_u32_u24 v2, v22, v3
    v_lshl_add_u32 v2, v23, 5, v2
    ds_write_b128 v2, v[56:59] offset:28672
    ds_write_b128 v2, v[60:63] offset:28688
    s_waitcnt lgkmcnt(0)
    s_barrier
    s_cmp_ge_u32 s69, 10
    s_cbranch_scc1 Lk1_end
    v_lshlrev_b32 v2, 2, v0
    ds_read_b32 v40, v2 offset:28672
    ds_read_b32 v41, v2 offset:31232
    ds_read_b32 v42, v2 offset:33792
    ds_read_b32 v43, v2 offset:36352
    ds_read_b32 v44, v2 offset:38912
    ds_read_b32 v45, v2 offset:41472
    ds_read_b32 v46, v2 offset:44032
    ds_read_b32 v47, v2 offset:46592
    ds_read_b32 v48, v2 offset:49152
    ds_read_b32 v49, v2 offset:51712
    ds_read_b32 v50, v2 offset:54272
    ds_read_b32 v51, v2 offset:56832
    s_waitcnt lgkmcnt(0)
    v_add_f32 v40, v40, v41
    v_add_f32 v40, v40, v42
    v_add_f32 v40, v40, v43
    v_add_f32 v40, v40, v44
    v_add_f32 v40, v40, v45
    v_add_f32 v40, v40, v46
    v_add_f32 v40, v40, v47
    v_add_f32 v40, v40, v48
    v_add_f32 v40, v40, v49
    v_add_f32 v40, v40, v50
    v_add_f32 v40, v40, v51
    v_add_u32 v2, s93, v2
    buffer_store_dword v40, v2, s[64:67], 0 offen
    s_branch Lk1_end
Lk1_end:
    s_endpgm
.p2align 8
gated_mix__mha_block_cached__dense_activation_silu__decode_k2_kernel:
    s_cmp_ge_u32 s2, 40
    s_cbranch_scc1 Lk2_end
    s_load_dwordx2 s[16:17], s[0:1], 0
    s_load_dwordx2 s[18:19], s[0:1], 64
    s_load_dwordx2 s[20:21], s[0:1], 72
    s_load_dwordx2 s[22:23], s[0:1], 88
    s_cmp_ge_u32 s2, 20
    s_cselect_b32 s3, 1, 0
    s_mul_i32 s4, s3, 20
    s_sub_u32 s4, s2, s4
    s_waitcnt lgkmcnt(0)
    s_mov_b32 s36, s16
    s_and_b32 s37, s17, 0xffff
    s_mov_b32 s38, 2560
    s_mov_b32 s39, 0x00020000
    s_mov_b32 s40, s18
    s_and_b32 s41, s19, 0xffff
    s_mov_b32 s42, 1280
    s_mov_b32 s43, 0x00020000
    s_mov_b32 s44, s20
    s_and_b32 s45, s21, 0xffff
    s_mov_b32 s46, 2560
    s_mov_b32 s47, 0x00020000
    s_mov_b32 s48, s22
    s_and_b32 s49, s23, 0xffff
    s_mov_b32 s50, 2097152
    s_mov_b32 s51, 0x00020000
    s_add_u32 s24, s22, 2097152
    s_addc_u32 s25, s23, 0
    s_mov_b32 s52, s24
    s_and_b32 s53, s25, 0xffff
    s_mov_b32 s54, 552960
    s_mov_b32 s55, 0x00020000
    v_lshrrev_b32 v1, 5, v0
    v_and_b32 v2, 31, v0
    v_and_b32 v3, 127, v0
    v_lshrrev_b32 v4, 2, v3
    v_and_b32 v5, 3, v3
    v_lshl_add_u32 v4, v5, 6, v4
    s_lshl_b32 s5, s3, 5
    v_add_u32 v4, s5, v4
    v_lshlrev_b32 v4, 3, v4
    v_add_u32 v4, 1048576, v4
    buffer_load_dwordx2 v[6:7], v4, s[48:51], 0 offen
    v_lshrrev_b32 v4, 2, v1
    v_and_b32 v5, 3, v1
    v_lshl_add_u32 v4, v5, 6, v4
    v_add_u32 v4, s5, v4
    v_mov_b32 v5, 2560
    v_mul_u32_u24 v4, v4, v5
    s_lshl_b32 s6, s4, 7
    v_lshl_add_u32 v4, v2, 2, v4
    v_add_u32 v4, s6, v4
    buffer_load_dword v16, v4, s[48:51], 0 offen
    v_add_u32 v4, 5120, v4
    buffer_load_dword v17, v4, s[48:51], 0 offen
    v_add_u32 v4, 5120, v4
    buffer_load_dword v18, v4, s[48:51], 0 offen
    v_add_u32 v4, 5120, v4
    buffer_load_dword v19, v4, s[48:51], 0 offen
    v_add_u32 v4, 5120, v4
    buffer_load_dword v20, v4, s[48:51], 0 offen
    v_add_u32 v4, 5120, v4
    buffer_load_dword v21, v4, s[48:51], 0 offen
    v_add_u32 v4, 5120, v4
    buffer_load_dword v22, v4, s[48:51], 0 offen
    v_add_u32 v4, 5120, v4
    buffer_load_dword v23, v4, s[48:51], 0 offen
    v_add_u32 v4, 5120, v4
    buffer_load_dword v24, v4, s[48:51], 0 offen
    v_add_u32 v4, 5120, v4
    buffer_load_dword v25, v4, s[48:51], 0 offen
    v_add_u32 v4, 5120, v4
    buffer_load_dword v26, v4, s[48:51], 0 offen
    v_add_u32 v4, 5120, v4
    buffer_load_dword v27, v4, s[48:51], 0 offen
    v_add_u32 v4, 5120, v4
    buffer_load_dword v28, v4, s[48:51], 0 offen
    v_add_u32 v4, 5120, v4
    buffer_load_dword v29, v4, s[48:51], 0 offen
    v_add_u32 v4, 5120, v4
    buffer_load_dword v30, v4, s[48:51], 0 offen
    v_add_u32 v4, 5120, v4
    buffer_load_dword v31, v4, s[48:51], 0 offen
    v_lshlrev_b32 v4, 1, v1
    v_add_u32 v4, s3, v4
    v_mul_u32_u24 v4, v4, v5
    v_lshl_add_u32 v4, v2, 2, v4
    v_add_u32 v4, s6, v4
    buffer_load_dword v32, v4, s[52:55], 0 offen
    v_add_u32 v4, 40960, v4
    buffer_load_dword v33, v4, s[52:55], 0 offen
    v_add_u32 v4, 40960, v4
    buffer_load_dword v34, v4, s[52:55], 0 offen
    v_add_u32 v4, 40960, v4
    buffer_load_dword v35, v4, s[52:55], 0 offen
    v_add_u32 v4, 40960, v4
    buffer_load_dword v36, v4, s[52:55], 0 offen
    v_add_u32 v4, 40960, v4
    buffer_load_dword v37, v4, s[52:55], 0 offen
    v_add_u32 v4, 40960, v4
    buffer_load_dword v38, v4, s[52:55], 0 offen
    v_add_u32 v4, 40960, v4
    buffer_load_dword v39, v4, s[52:55], 0 offen
    v_add_u32 v4, 40960, v4
    buffer_load_dword v40, v4, s[52:55], 0 offen
    v_add_u32 v4, 40960, v4
    buffer_load_dword v41, v4, s[52:55], 0 offen
    v_add_u32 v4, 40960, v4
    buffer_load_dword v42, v4, s[52:55], 0 offen
    v_add_u32 v4, 40960, v4
    buffer_load_dword v43, v4, s[52:55], 0 offen
    v_add_u32 v4, 40960, v4
    buffer_load_dword v44, v4, s[52:55], 0 offen
    v_add_u32 v4, 40960, v4
    buffer_load_dword v45, v4, s[52:55], 0 offen
    v_and_b32 v4, 63, v0
    v_mul_u32_u24 v4, 20, v4
    s_mul_i32 s7, s3, 1280
    v_add_u32 v5, s7, v4
    buffer_load_dwordx4 v[48:51], v5, s[36:39], 0 offen
    buffer_load_dword v52, v5, s[36:39], 0 offen offset:16
    buffer_load_dwordx4 v[56:59], v4, s[40:43], 0 offen
    buffer_load_dword v60, v4, s[40:43], 0 offen offset:16
    s_waitcnt vmcnt(34)
    v_mov_b32 v8, v6
    s_nop 1
    v_max_f32_dpp v8, v8, v8 quad_perm:[1,0,3,2] row_mask:0xf bank_mask:0xf
    s_nop 1
    v_max_f32_dpp v8, v8, v8 quad_perm:[2,3,0,1] row_mask:0xf bank_mask:0xf
    v_sub_f32 v9, v6, v8
    v_mul_f32 v9, 0x3fb8aa3b, v9
    v_exp_f32 v9, v9
    s_nop 0
    v_mul_f32 v10, v9, v7
    s_nop 1
    v_add_f32_dpp v10, v10, v10 quad_perm:[1,0,3,2] row_mask:0xf bank_mask:0xf
    s_nop 1
    v_add_f32_dpp v10, v10, v10 quad_perm:[2,3,0,1] row_mask:0xf bank_mask:0xf
    v_rcp_f32 v10, v10
    s_nop 0
    v_mul_f32 v9, v9, v10
    v_lshlrev_b32 v4, 2, v3
    ds_write_b32 v4, v9 offset:0
    s_waitcnt lgkmcnt(0)
    s_barrier
    v_lshlrev_b32 v4, 2, v1
    ds_read_b32 v64, v4 offset:0
    ds_read_b32 v65, v4 offset:32
    ds_read_b32 v66, v4 offset:64
    ds_read_b32 v67, v4 offset:96
    ds_read_b32 v68, v4 offset:128
    ds_read_b32 v69, v4 offset:160
    ds_read_b32 v70, v4 offset:192
    ds_read_b32 v71, v4 offset:224
    ds_read_b32 v72, v4 offset:256
    ds_read_b32 v73, v4 offset:288
    ds_read_b32 v74, v4 offset:320
    ds_read_b32 v75, v4 offset:352
    ds_read_b32 v76, v4 offset:384
    ds_read_b32 v77, v4 offset:416
    ds_read_b32 v78, v4 offset:448
    ds_read_b32 v79, v4 offset:480
    s_waitcnt lgkmcnt(0)
    s_waitcnt vmcnt(18)
    v_mul_f32 v8, v16, v64
    v_fmac_f32 v8, v17, v65
    v_fmac_f32 v8, v18, v66
    v_fmac_f32 v8, v19, v67
    v_fmac_f32 v8, v20, v68
    v_fmac_f32 v8, v21, v69
    v_fmac_f32 v8, v22, v70
    v_fmac_f32 v8, v23, v71
    v_fmac_f32 v8, v24, v72
    v_fmac_f32 v8, v25, v73
    v_fmac_f32 v8, v26, v74
    v_fmac_f32 v8, v27, v75
    v_fmac_f32 v8, v28, v76
    v_fmac_f32 v8, v29, v77
    v_fmac_f32 v8, v30, v78
    v_fmac_f32 v8, v31, v79
    s_waitcnt vmcnt(4)
    v_add_f32 v9, v32, v33
    v_add_f32 v9, v9, v34
    v_add_f32 v9, v9, v35
    v_add_f32 v9, v9, v36
    v_add_f32 v9, v9, v37
    v_add_f32 v9, v9, v38
    v_add_f32 v9, v9, v39
    v_add_f32 v9, v9, v40
    v_add_f32 v9, v9, v41
    v_add_f32 v9, v9, v42
    v_add_f32 v9, v9, v43
    v_add_f32 v9, v9, v44
    v_add_f32 v9, v9, v45
    v_lshlrev_b32 v4, 2, v0
    ds_write_b32 v4, v8 offset:512
    ds_write_b32 v4, v9 offset:1536
    s_waitcnt vmcnt(0)
    v_mov_b32 v10, 0
    v_lshlrev_b32 v11, 16, v48
    v_lshlrev_b32 v12, 16, v56
    v_mul_f32 v11, v11, v12
    v_and_b32 v12, 0xffff0000, v48
    v_and_b32 v13, 0xffff0000, v56
    v_mul_f32 v12, v12, v13
    v_cvt_pk_bf16_f32 v11, v11, v12
    v_lshlrev_b32 v12, 16, v11
    v_and_b32 v11, 0xffff0000, v11
    v_add_f32 v10, v10, v12
    v_add_f32 v10, v10, v11
    v_lshlrev_b32 v11, 16, v49
    v_lshlrev_b32 v12, 16, v57
    v_mul_f32 v11, v11, v12
    v_and_b32 v12, 0xffff0000, v49
    v_and_b32 v13, 0xffff0000, v57
    v_mul_f32 v12, v12, v13
    v_cvt_pk_bf16_f32 v11, v11, v12
    v_lshlrev_b32 v12, 16, v11
    v_and_b32 v11, 0xffff0000, v11
    v_add_f32 v10, v10, v12
    v_add_f32 v10, v10, v11
    v_lshlrev_b32 v11, 16, v50
    v_lshlrev_b32 v12, 16, v58
    v_mul_f32 v11, v11, v12
    v_and_b32 v12, 0xffff0000, v50
    v_and_b32 v13, 0xffff0000, v58
    v_mul_f32 v12, v12, v13
    v_cvt_pk_bf16_f32 v11, v11, v12
    v_lshlrev_b32 v12, 16, v11
    v_and_b32 v11, 0xffff0000, v11
    v_add_f32 v10, v10, v12
    v_add_f32 v10, v10, v11
    v_lshlrev_b32 v11, 16, v51
    v_lshlrev_b32 v12, 16, v59
    v_mul_f32 v11, v11, v12
    v_and_b32 v12, 0xffff0000, v51
    v_and_b32 v13, 0xffff0000, v59
    v_mul_f32 v12, v12, v13
    v_cvt_pk_bf16_f32 v11, v11, v12
    v_lshlrev_b32 v12, 16, v11
    v_and_b32 v11, 0xffff0000, v11
    v_add_f32 v10, v10, v12
    v_add_f32 v10, v10, v11
    v_lshlrev_b32 v11, 16, v52
    v_lshlrev_b32 v12, 16, v60
    v_mul_f32 v11, v11, v12
    v_and_b32 v12, 0xffff0000, v52
    v_and_b32 v13, 0xffff0000, v60
    v_mul_f32 v12, v12, v13
    v_cvt_pk_bf16_f32 v11, v11, v12
    v_lshlrev_b32 v12, 16, v11
    v_and_b32 v11, 0xffff0000, v11
    v_add_f32 v10, v10, v12
    v_add_f32 v10, v10, v11
    s_nop 1
    v_add_f32_dpp v10, v10, v10 row_ror:8 row_mask:0xf bank_mask:0xf
    s_nop 1
    v_add_f32_dpp v10, v10, v10 row_ror:4 row_mask:0xf bank_mask:0xf
    s_nop 1
    v_add_f32_dpp v10, v10, v10 row_ror:2 row_mask:0xf bank_mask:0xf
    s_nop 1
    v_add_f32_dpp v10, v10, v10 row_ror:1 row_mask:0xf bank_mask:0xf
    v_mov_b32 v11, v10
    s_nop 1
    v_permlane16_swap_b32 v10, v11
    v_add_f32 v10, v10, v11
    v_mov_b32 v11, v10
    s_nop 1
    v_permlane32_swap_b32 v10, v11
    v_add_f32 v10, v10, v11
    v_cvt_pk_bf16_f32 v10, v10, v10
    v_lshlrev_b32 v10, 16, v10
    v_mul_f32 v10, 0xbfb8aa3b, v10
    v_exp_f32 v10, v10
    s_nop 0
    v_add_f32 v10, 1.0, v10
    v_rcp_f32 v10, v10
    s_nop 0
    v_cvt_pk_bf16_f32 v10, v10, v10
    v_lshlrev_b32 v10, 16, v10
    v_sub_f32 v11, 1.0, v10
    v_cvt_pk_bf16_f32 v11, v11, v11
    v_lshlrev_b32 v11, 16, v11
    s_waitcnt lgkmcnt(0)
    s_barrier
    v_lshlrev_b32 v4, 2, v2
    ds_read_b32 v16, v4 offset:512
    ds_read_b32 v32, v4 offset:1536
    ds_read_b32 v17, v4 offset:640
    ds_read_b32 v33, v4 offset:1664
    ds_read_b32 v18, v4 offset:768
    ds_read_b32 v34, v4 offset:1792
    ds_read_b32 v19, v4 offset:896
    ds_read_b32 v35, v4 offset:1920
    ds_read_b32 v20, v4 offset:1024
    ds_read_b32 v36, v4 offset:2048
    ds_read_b32 v21, v4 offset:1152
    ds_read_b32 v37, v4 offset:2176
    ds_read_b32 v22, v4 offset:1280
    ds_read_b32 v38, v4 offset:2304
    ds_read_b32 v23, v4 offset:1408
    ds_read_b32 v39, v4 offset:2432
    s_waitcnt lgkmcnt(0)
    v_add_f32 v16, v16, v17
    v_add_f32 v32, v32, v33
    v_add_f32 v16, v16, v18
    v_add_f32 v32, v32, v34
    v_add_f32 v16, v16, v19
    v_add_f32 v32, v32, v35
    v_add_f32 v16, v16, v20
    v_add_f32 v32, v32, v36
    v_add_f32 v16, v16, v21
    v_add_f32 v32, v32, v37
    v_add_f32 v16, v16, v22
    v_add_f32 v32, v32, v38
    v_add_f32 v16, v16, v23
    v_add_f32 v32, v32, v39
    v_cvt_pk_bf16_f32 v16, v16, v32
    v_lshlrev_b32 v17, 16, v16
    v_and_b32 v18, 0xffff0000, v16
    v_mul_f32 v17, v10, v17
    v_mul_f32 v18, v11, v18
    v_cvt_pk_bf16_f32 v16, v17, v18
    v_lshlrev_b32 v17, 16, v16
    v_and_b32 v18, 0xffff0000, v16
    v_add_f32 v17, v17, v18
    v_cvt_pk_bf16_f32 v17, v17, v17
    v_cmp_gt_u32 vcc, 32, v0
    s_and_saveexec_b64 s[8:9], vcc
    s_cbranch_execz Lk2_end
    v_lshlrev_b32 v4, 1, v2
    s_lshl_b32 s6, s4, 6
    v_add_u32 v4, s6, v4
    v_add_u32 v4, s7, v4
    buffer_store_short v17, v4, s[44:47], 0 offen
Lk2_end:
    s_endpgm
.section .rodata,"a"
.p2align 6
.amdhsa_kernel gated_mix__mha_block_cached__dense_activation_silu__decode_k1_kernel
  .amdhsa_next_free_vgpr 128
  .amdhsa_next_free_sgpr 96
  .amdhsa_accum_offset 128
  .amdhsa_group_segment_fixed_size 0
  .amdhsa_kernarg_size 96
  .amdhsa_user_sgpr_count 2
  .amdhsa_user_sgpr_kernarg_segment_ptr 1
  .amdhsa_system_sgpr_workgroup_id_x 1
.end_amdhsa_kernel
.p2align 6
.amdhsa_kernel gated_mix__mha_block_cached__dense_activation_silu__decode_k2_kernel
  .amdhsa_next_free_vgpr 96
  .amdhsa_next_free_sgpr 96
  .amdhsa_accum_offset 96
  .amdhsa_group_segment_fixed_size 0
  .amdhsa_kernarg_size 96
  .amdhsa_user_sgpr_count 2
  .amdhsa_user_sgpr_kernarg_segment_ptr 1
  .amdhsa_system_sgpr_workgroup_id_x 1
.end_amdhsa_kernel
```
